```python
import torch

def _softmax(x, axis=-1):
    return torch.softmax(x, dim=axis)
def _gelu(x):
    return torch.nn.functional.gelu(x, approximate="tanh")
def _silu(x):
    return torch.nn.functional.silu(x)
def _sigmoid(x):
    return torch.sigmoid(x)
def _layernorm(x, axis=-1, eps=1e-5):
    m = x.mean(dim=axis, keepdim=True)
    v = x.var(dim=axis, keepdim=True, unbiased=False)
    return (x - m) / torch.sqrt(v + eps)
def _scatter_add(tgt, idx, src, axis=0):
    return tgt.clone().index_add_(axis, idx, src)
def _segment_sum(src, seg, n):
    out = torch.zeros((n,) + src.shape[1:], dtype=src.dtype)
    return out.index_add_(0, seg, src)
def _pad(x, pw):
    flat = tuple(v for pair in reversed(pw) for v in pair)
    return torch.nn.functional.pad(x, flat)

kernel_name = 'recurrent_scan__sliding_block_cached__dense_activation_gelu__decode'

def setup_inputs():

    _w = (lambda a: (lambda t: t.to(torch.bfloat16) if t.is_floating_point() else t)(torch.as_tensor(a)))
    def _A_setup():
        B, Sq, D = 8, 1, 512
        Hq, Hkv, Sk, Dh = 32, 8, 4096, 128
        assert Hq % Hkv == 0, (Hq, Hkv)
        return {
            "x": _w((lambda *s: torch.randn(*s, dtype=torch.bfloat16) * 0.05)(B, Sq, D)),
            "k_cache": _w((lambda *s: torch.randn(*s, dtype=torch.bfloat16) * 3.2)(B, Hkv, Sk, Dh)),
            "v_cache": _w((lambda *s: torch.randn(*s, dtype=torch.bfloat16) * 3.2)(B, Hkv, Sk, Dh)),
            "wq": _w((lambda *s: torch.randn(*s, dtype=torch.bfloat16) * 3.2)(D, Hq * Dh) * (D ** -0.5)),
            "wo": _w((lambda *s: torch.randn(*s, dtype=torch.bfloat16) * 3.2)(Hq * Dh, D) * ((Hq * Dh) ** -0.5)),
        }
    _A_in = _A_setup()

    def _B_setup():
        B, S, D, F = 8, 1, 512, 1792
        return {
            "x": _w((lambda *s: torch.randn(*s, dtype=torch.bfloat16) * 0.05)(B, S, D)),
            "w1": _w((lambda *s: torch.randn(*s, dtype=torch.bfloat16) * 3.2)(D, F) * (D ** -0.5)),
            "b1": _w((lambda *s: torch.randn(*s, dtype=torch.bfloat16) * 3.2)(F) * 0.01),
            "w2": _w((lambda *s: torch.randn(*s, dtype=torch.bfloat16) * 0.4)(F, D) * (F ** -0.5)),
            "b2": _w((lambda *s: torch.randn(*s, dtype=torch.bfloat16) * 0.4)(D) * 0.01),
        }
    _B_in = _B_setup()

    return {
        "A_x": _A_in["x"],
        "A_k_cache": _A_in["k_cache"],
        "A_v_cache": _A_in["v_cache"],
        "A_wq": _A_in["wq"],
        "A_wo": _A_in["wo"],
        "B_x": _B_in["x"],
        "B_w1": _B_in["w1"],
        "B_b1": _B_in["b1"],
        "B_w2": _B_in["w2"],
        "B_b2": _B_in["b2"],
    }

def reference(A_x, A_k_cache, A_v_cache, A_wq, A_wo, B_x, B_w1, B_b1, B_w2, B_b2):
    def _A_ref(x, k_cache, v_cache, wq, wo):
        B, Sq, D = x.shape
        Hq, Dh = 32, 128
        Hkv, Sk = k_cache.shape[1], k_cache.shape[2]
        W = min(4096, max(256, Sk // 4))
        rep = Hq // Hkv
        q = (lambda x, *d: x.permute(*d))((x @ wq).reshape(B, Sq, Hq, Dh), 0, 2, 1, 3)
        k = (lambda x, n, axis: torch.repeat_interleave(x, n, dim=axis))(k_cache[:, :, Sk - W:, :], rep, axis=1)
        v = (lambda x, n, axis: torch.repeat_interleave(x, n, dim=axis))(v_cache[:, :, Sk - W:, :], rep, axis=1)
        scores = torch.einsum("bhqd,bhkd->bhqk", q, k) * (Dh ** -0.5)
        p = _softmax(scores, axis=-1)
        o = torch.einsum("bhqk,bhkd->bhqd", p, v)
        return (lambda x, *d: x.permute(*d))(o, 0, 2, 1, 3).reshape(B, Sq, Hq * Dh) @ wo

    def _B_ref(x, w1, b1, w2, b2):
        h = torch.einsum("bsd,df->bsf", x, w1) + b1
        h = _gelu(h)
        return torch.einsum("bsf,fd->bsd", h, w2) + b2

    x = A_x
    xn = _layernorm(x, axis=-1)
    s = _A_ref(xn, A_k_cache, A_v_cache, A_wq, A_wo)
    g = _silu(_B_ref(xn, B_w1, B_b1, B_w2, B_b2))
    return x + s * g
```

```asm
; @launch grid=(256,1,1) block=(768,1,1) lds=139264
.amdgcn_target "amdgcn-amd-amdhsa--gfx950"
.text
.globl recurrent_scan__sliding_block_cached__dense_activation_gelu__decode_kernel
.p2align 8
.type recurrent_scan__sliding_block_cached__dense_activation_gelu__decode_kernel,@function
recurrent_scan__sliding_block_cached__dense_activation_gelu__decode_kernel:
    s_cmp_ge_u32 s2, 256
    s_cbranch_scc1 L_end
    s_load_dwordx16 s[64:79], s[0:1], 0
    s_load_dwordx8 s[80:87], s[0:1], 64
    s_load_dwordx2 s[88:89], s[0:1], 96
    s_lshr_b32 s20, s2, 5
    s_and_b32 s21, s2, 31
    s_lshl_b32 s2, s21, 3
    s_add_u32 s2, s2, s20
    s_lshr_b32 s22, s21, 2
    s_and_b32 s23, s21, 3
    v_lshrrev_b32 v1, 6, v0
    v_and_b32 v2, 63, v0
    v_readfirstlane_b32 s30, v1
    s_lshl_b32 s24, s22, 3
    s_add_u32 s24, s24, s20
    s_lshl_b32 s24, s24, 20
    s_add_u32 s24, s24, 0xC0000
    s_lshl_b32 s25, s23, 16
    s_add_u32 s25, s25, s24
    v_and_b32 v3, 15, v2
    v_lshrrev_b32 v4, 4, v2
    v_mov_b32 v125, 134912
    v_mov_b32 v124, 0x7fc00000
    s_waitcnt lgkmcnt(0)
    s_cmp_ge_u32 s30, 8
    s_cbranch_scc1 L_ctrl
    s_mov_b32 s8, s66
    s_mov_b32 s9, s67
    s_mov_b32 s10, 0x4000000
    s_mov_b32 s11, 0x20000
    s_mov_b32 s12, s68
    s_mov_b32 s13, s69
    s_mov_b32 s14, 0x4000000
    s_mov_b32 s15, 0x20000
    s_mov_b32 s44, s72
    s_mov_b32 s45, s73
    s_mov_b32 s46, 0x400000
    s_mov_b32 s47, 0x20000
    s_mov_b32 s52, s80
    s_mov_b32 s53, s81
    s_mov_b32 s54, 0x1c0000
    s_mov_b32 s55, 0x20000
    s_lshl_b32 s31, s30, 13
    s_add_u32 s26, s31, s25
    s_add_u32 s27, s26, 4096
    v_add_u32 v5, 0, v4
    v_xor_b32 v5, v5, v3
    v_lshlrev_b32 v5, 4, v5
    v_lshl_add_u32 v6, v4, 8, v5
    v_add_u32 v5, 4, v4
    v_xor_b32 v5, v5, v3
    v_lshlrev_b32 v5, 4, v5
    v_lshl_add_u32 v7, v4, 8, v5
    v_add_u32 v5, 8, v4
    v_xor_b32 v5, v5, v3
    v_lshlrev_b32 v5, 4, v5
    v_lshl_add_u32 v8, v4, 8, v5
    v_add_u32 v5, 12, v4
    v_xor_b32 v5, v5, v3
    v_lshlrev_b32 v5, 4, v5
    v_lshl_add_u32 v9, v4, 8, v5
    v_lshrrev_b32 v10, 3, v2
    v_lshlrev_b32 v10, 10, v10
    v_and_b32 v11, 7, v2
    v_lshl_add_u32 v10, v11, 4, v10
    s_mul_i32 s32, s21, 56
    s_lshl_b32 s33, s30, 3
    s_add_u32 s32, s32, s33
    s_lshl_b32 s32, s32, 10
    s_lshl_b32 s33, s20, 7
    s_add_u32 s32, s32, s33
    s_lshl_b32 s33, s30, 10
    s_add_u32 s33, s33, 114688
    v_lshlrev_b32 v12, 4, v2
    v_add_u32 v12, s31, v12
    v_add_u32 v13, 4096, v12
    v_lshlrev_b32 v14, 10, v4
    v_lshl_add_u32 v14, v3, 4, v14
    s_lshl_b32 s34, s20, 9
    s_lshl_b32 s35, s22, 6
    s_add_u32 s34, s34, s35
    s_lshl_b32 s35, s30, 3
    s_add_u32 s34, s34, s35
    s_lshl_b32 s34, s34, 10
    s_lshl_b32 s35, s23, 8
    s_add_u32 s34, s34, s35
    s_lshl_b32 s35, s30, 11
    s_add_u32 s35, s35, 98304
    v_and_b32 v15, 7, v3
    v_and_b32 v16, 1, v15
    v_lshrrev_b32 v17, 1, v15
    v_mov_b32 v18, 0xffff
    v_mov_b32 v19, 0xffff0000
    v_cmp_eq_u32 vcc, 1, v16
    s_nop 1
    v_cndmask_b32 v18, v18, v19, vcc
    v_cmp_eq_u32 vcc, 0, v17
    s_nop 1
    v_cndmask_b32 v112, 0, v18, vcc
    v_cmp_eq_u32 vcc, 1, v17
    s_nop 1
    v_cndmask_b32 v113, 0, v18, vcc
    v_cmp_eq_u32 vcc, 2, v17
    s_nop 1
    v_cndmask_b32 v114, 0, v18, vcc
    v_cmp_eq_u32 vcc, 3, v17
    s_nop 1
    v_cndmask_b32 v115, 0, v18, vcc
    s_barrier
    s_mov_b32 m0, s31
    s_nop 0
    buffer_load_dwordx4 v6, s[8:11], s26 offen offset:0 nt lds
    buffer_load_dwordx4 v7, s[8:11], s26 offen offset:1024 nt lds
    s_waitcnt vmcnt(1)
    buffer_load_dwordx4 v8, s[8:11], s26 offen offset:2048 nt lds
    s_waitcnt vmcnt(1)
    buffer_load_dwordx4 v9, s[8:11], s26 offen offset:3072 nt lds
    s_waitcnt vmcnt(1)
    s_add_u32 m0, s31, 4096
    s_nop 0
    buffer_load_dwordx4 v6, s[8:11], s27 offen offset:0 nt lds
    s_waitcnt vmcnt(1)
    buffer_load_dwordx4 v7, s[8:11], s27 offen offset:1024 nt lds
    s_waitcnt vmcnt(1)
    buffer_load_dwordx4 v8, s[8:11], s27 offen offset:2048 nt lds
    s_waitcnt vmcnt(1)
    buffer_load_dwordx4 v9, s[8:11], s27 offen offset:3072 nt lds
    s_waitcnt vmcnt(1)
    s_cmp_eq_u32 s30, 7
    s_cbranch_scc1 L_w2zero
    s_mov_b32 m0, s33
    s_nop 0
    buffer_load_dwordx4 v10, s[52:55], s32 offen nt lds
    s_branch L_w2done
L_w2zero:
    v_mov_b32 v116, 0
    v_mov_b32 v117, 0
    v_mov_b32 v118, 0
    v_mov_b32 v119, 0
    v_lshlrev_b32 v11, 4, v2
    v_add_u32 v11, 121856, v11
    ds_write_b128 v11, v[116:119]
    buffer_load_dwordx4 v[116:119], v10, s[52:55], 0 offen
L_w2done:
    s_waitcnt vmcnt(1)
    buffer_load_dwordx4 v[16:19], v12, s[12:15], s25 offen offset:0 nt
    s_waitcnt vmcnt(1)
    s_waitcnt lgkmcnt(0)
    v_mov_b32 v123, 1
    s_mov_b64 s[36:37], exec
    s_mov_b64 exec, 1
    ds_add_u32 v125, v123 offset:16
    s_mov_b64 exec, s[36:37]
    buffer_load_dwordx4 v[20:23], v12, s[12:15], s25 offen offset:1024 nt
    s_waitcnt vmcnt(1)
    buffer_load_dwordx4 v[24:27], v12, s[12:15], s25 offen offset:2048 nt
    s_waitcnt vmcnt(1)
    buffer_load_dwordx4 v[28:31], v12, s[12:15], s25 offen offset:3072 nt
    s_waitcnt vmcnt(1)
    buffer_load_dwordx4 v[32:35], v13, s[12:15], s25 offen offset:0 nt
    s_waitcnt vmcnt(1)
    buffer_load_dwordx4 v[36:39], v13, s[12:15], s25 offen offset:1024 nt
    s_waitcnt vmcnt(1)
    buffer_load_dwordx4 v[40:43], v13, s[12:15], s25 offen offset:2048 nt
    s_waitcnt vmcnt(1)
    buffer_load_dwordx4 v[44:47], v13, s[12:15], s25 offen offset:3072 nt
    s_waitcnt vmcnt(1)
    s_mov_b32 m0, s35
    s_nop 0
    buffer_load_dwordx4 v14, s[44:47], s34 offen nt lds
    s_waitcnt vmcnt(1)
    s_add_u32 m0, s35, 1024
    s_add_u32 s34, s34, 4096
    buffer_load_dwordx4 v14, s[44:47], s34 offen nt lds
    s_mov_b32 s96, 0
L_lw1:
    ds_read_b32 v123, v125 offset:20
    s_waitcnt lgkmcnt(0)
    v_cmp_gt_u32 vcc, 4, v123
    s_cbranch_vccz L_lw1_d
    s_sleep 1
    s_add_u32 s96, s96, 1
    s_cmp_lt_u32 s96, 4000
    s_cbranch_scc1 L_lw1
L_lw1_d:
    v_lshrrev_b32 v5, 3, v3
    v_lshlrev_b32 v5, 7, v5
    v_lshl_add_u32 v5, v4, 5, v5
    s_lshl_b32 s33, s30, 9
    s_add_u32 s33, s33, 135168
    v_add_u32 v5, s33, v5
    ds_read_b128 v[80:83], v5
    ds_read_b128 v[84:87], v5 offset:16
    ds_read_b128 v[88:91], v5 offset:256
    ds_read_b128 v[92:95], v5 offset:272
    v_mov_b32 v96, 0
    v_mov_b32 v97, 0
    v_mov_b32 v98, 0
    v_mov_b32 v99, 0
    v_mov_b32 v100, 0
    v_mov_b32 v101, 0
    v_mov_b32 v102, 0
    v_mov_b32 v103, 0
    s_waitcnt lgkmcnt(0)
    v_and_b32 v48, v80, v112
    v_and_b32 v49, v80, v113
    v_and_b32 v50, v80, v114
    v_and_b32 v51, v80, v115
    v_and_b32 v52, v88, v112
    v_and_b32 v53, v88, v113
    v_and_b32 v54, v88, v114
    v_and_b32 v55, v88, v115
    s_waitcnt vmcnt(9)
    v_mfma_f32_16x16x32_bf16 v[96:99], v[16:19], v[48:51], v[96:99]
    v_mfma_f32_16x16x32_bf16 v[100:103], v[16:19], v[52:55], v[100:103]
    v_and_b32 v56, v81, v112
    v_and_b32 v57, v81, v113
    v_and_b32 v58, v81, v114
    v_and_b32 v59, v81, v115
    v_and_b32 v60, v89, v112
    v_and_b32 v61, v89, v113
    v_and_b32 v62, v89, v114
    v_and_b32 v63, v89, v115
    s_waitcnt vmcnt(8)
    v_mfma_f32_16x16x32_bf16 v[96:99], v[20:23], v[56:59], v[96:99]
    v_mfma_f32_16x16x32_bf16 v[100:103], v[20:23], v[60:63], v[100:103]
    v_and_b32 v64, v82, v112
    v_and_b32 v65, v82, v113
    v_and_b32 v66, v82, v114
    v_and_b32 v67, v82, v115
    v_and_b32 v68, v90, v112
    v_and_b32 v69, v90, v113
    v_and_b32 v70, v90, v114
    v_and_b32 v71, v90, v115
    s_waitcnt vmcnt(7)
    v_mfma_f32_16x16x32_bf16 v[96:99], v[24:27], v[64:67], v[96:99]
    v_mfma_f32_16x16x32_bf16 v[100:103], v[24:27], v[68:71], v[100:103]
    v_and_b32 v72, v83, v112
    v_and_b32 v73, v83, v113
    v_and_b32 v74, v83, v114
    v_and_b32 v75, v83, v115
    v_and_b32 v76, v91, v112
    v_and_b32 v77, v91, v113
    v_and_b32 v78, v91, v114
    v_and_b32 v79, v91, v115
    s_waitcnt vmcnt(6)
    v_mfma_f32_16x16x32_bf16 v[96:99], v[28:31], v[72:75], v[96:99]
    v_mfma_f32_16x16x32_bf16 v[100:103], v[28:31], v[76:79], v[100:103]
    v_and_b32 v48, v84, v112
    v_and_b32 v49, v84, v113
    v_and_b32 v50, v84, v114
    v_and_b32 v51, v84, v115
    v_and_b32 v52, v92, v112
    v_and_b32 v53, v92, v113
    v_and_b32 v54, v92, v114
    v_and_b32 v55, v92, v115
    s_waitcnt vmcnt(5)
    v_mfma_f32_16x16x32_bf16 v[96:99], v[32:35], v[48:51], v[96:99]
    v_mfma_f32_16x16x32_bf16 v[100:103], v[32:35], v[52:55], v[100:103]
    v_and_b32 v56, v85, v112
    v_and_b32 v57, v85, v113
    v_and_b32 v58, v85, v114
    v_and_b32 v59, v85, v115
    v_and_b32 v60, v93, v112
    v_and_b32 v61, v93, v113
    v_and_b32 v62, v93, v114
    v_and_b32 v63, v93, v115
    s_waitcnt vmcnt(4)
    v_mfma_f32_16x16x32_bf16 v[96:99], v[36:39], v[56:59], v[96:99]
    v_mfma_f32_16x16x32_bf16 v[100:103], v[36:39], v[60:63], v[100:103]
    v_and_b32 v64, v86, v112
    v_and_b32 v65, v86, v113
    v_and_b32 v66, v86, v114
    v_and_b32 v67, v86, v115
    v_and_b32 v68, v94, v112
    v_and_b32 v69, v94, v113
    v_and_b32 v70, v94, v114
    v_and_b32 v71, v94, v115
    s_waitcnt vmcnt(3)
    v_mfma_f32_16x16x32_bf16 v[96:99], v[40:43], v[64:67], v[96:99]
    v_mfma_f32_16x16x32_bf16 v[100:103], v[40:43], v[68:71], v[100:103]
    v_and_b32 v72, v87, v112
    v_and_b32 v73, v87, v113
    v_and_b32 v74, v87, v114
    v_and_b32 v75, v87, v115
    v_and_b32 v76, v95, v112
    v_and_b32 v77, v95, v113
    v_and_b32 v78, v95, v114
    v_and_b32 v79, v95, v115
    s_waitcnt vmcnt(2)
    v_mfma_f32_16x16x32_bf16 v[96:99], v[44:47], v[72:75], v[96:99]
    v_mfma_f32_16x16x32_bf16 v[100:103], v[44:47], v[76:79], v[100:103]
    s_lshl_b32 s33, s30, 11
    s_add_u32 s33, s33, 65536
    v_lshlrev_b32 v9, 4, v2
    v_add_u32 v9, s33, v9
    s_nop 7
    ds_write_b128 v9, v[96:99]
    ds_write_b128 v9, v[100:103] offset:1024
    s_waitcnt vmcnt(0)
    s_waitcnt lgkmcnt(0)
    v_mov_b32 v123, 1
    s_mov_b64 s[36:37], exec
    s_mov_b64 exec, 1
    ds_add_u32 v125, v123 offset:8
    s_mov_b64 exec, s[36:37]
    s_mov_b32 s96, 0
L_lw2:
    ds_read_b32 v123, v125 offset:8
    s_waitcnt lgkmcnt(0)
    v_cmp_gt_u32 vcc, 8, v123
    s_cbranch_vccz L_lw2_d
    s_sleep 1
    s_add_u32 s96, s96, 1
    s_cmp_lt_u32 s96, 4000
    s_cbranch_scc1 L_lw2
L_lw2_d:
    v_lshrrev_b32 v10, 2, v3
    v_lshl_add_u32 v10, v4, 3, v10
    v_lshlrev_b32 v10, 8, v10
    v_and_b32 v11, 3, v3
    v_lshl_add_u32 v10, v11, 3, v10
    s_lshl_b32 s33, s30, 5
    s_add_u32 s33, s33, 98304
    v_add_u32 v10, s33, v10
    s_cmp_ge_u32 s30, 2
    s_cbranch_scc1 L_nored
    s_lshl_b32 s33, s30, 10
    v_lshlrev_b32 v9, 4, v2
    v_add_u32 v9, s33, v9
    v_add_u32 v5, 65536, v9
    ds_read_b128 v[48:51], v5 offset:0
    ds_read_b128 v[52:55], v5 offset:2048
    ds_read_b128 v[56:59], v5 offset:4096
    ds_read_b128 v[60:63], v5 offset:6144
    ds_read_b128 v[64:67], v5 offset:8192
    ds_read_b128 v[68:71], v5 offset:10240
    ds_read_b128 v[72:75], v5 offset:12288
    ds_read_b128 v[76:79], v5 offset:14336
    s_lshl_b32 s33, s2, 12
    s_add_u32 s33, s33, 2097152
    v_add_u32 v9, s33, v9
    s_waitcnt lgkmcnt(0)
    v_add_f32 v48, v48, v52
    v_add_f32 v56, v56, v60
    v_add_f32 v64, v64, v68
    v_add_f32 v72, v72, v76
    v_add_f32 v49, v49, v53
    v_add_f32 v57, v57, v61
    v_add_f32 v65, v65, v69
    v_add_f32 v73, v73, v77
    v_add_f32 v50, v50, v54
    v_add_f32 v58, v58, v62
    v_add_f32 v66, v66, v70
    v_add_f32 v74, v74, v78
    v_add_f32 v51, v51, v55
    v_add_f32 v59, v59, v63
    v_add_f32 v67, v67, v71
    v_add_f32 v75, v75, v79
    v_add_f32 v48, v48, v56
    v_add_f32 v64, v64, v72
    v_add_f32 v49, v49, v57
    v_add_f32 v65, v65, v73
    v_add_f32 v50, v50, v58
    v_add_f32 v66, v66, v74
    v_add_f32 v51, v51, v59
    v_add_f32 v67, v67, v75
    v_add_f32 v48, v48, v64
    v_add_f32 v49, v49, v65
    v_add_f32 v50, v50, v66
    v_add_f32 v51, v51, v67
    v_cmp_eq_u32 vcc, -1, v48
    s_nop 1
    v_cndmask_b32 v48, v48, v124, vcc
    v_cmp_eq_u32 vcc, -1, v49
    s_nop 1
    v_cndmask_b32 v49, v49, v124, vcc
    v_cmp_eq_u32 vcc, -1, v50
    s_nop 1
    v_cndmask_b32 v50, v50, v124, vcc
    v_cmp_eq_u32 vcc, -1, v51
    s_nop 1
    v_cndmask_b32 v51, v51, v124, vcc
    global_store_dwordx4 v9, v[48:51], s[88:89] sc1
    s_branch L_nostat
L_nored:
    s_cmp_lg_u32 s30, 2
    s_cbranch_scc1 L_nostat
    v_and_b32 v15, 7, v2
    v_lshrrev_b32 v5, 1, v15
    v_lshlrev_b32 v5, 4, v5
    v_and_b32 v6, 1, v15
    v_lshl_add_u32 v5, v6, 7, v5
    v_add_u32 v5, 134656, v5
    ds_read_b128 v[56:59], v5
    s_waitcnt lgkmcnt(0)
    v_max3_f32 v8, v56, v57, v58
    v_max_f32 v8, v8, v59
    v_add_f32 v66, v56, v57
    v_add_f32 v66, v66, v58
    v_add_f32 v66, v66, v59
    v_cmp_eq_u32 vcc, 0, v6
    s_nop 1
    v_cndmask_b32 v66, v66, v8, vcc
    v_cmp_eq_u32 vcc, -1, v66
    s_nop 1
    v_cndmask_b32 v66, v66, v124, vcc
    s_lshl_b32 s33, s2, 12
    s_add_u32 s33, s33, 2099200
    v_lshlrev_b32 v7, 2, v2
    v_add_u32 v7, s33, v7
    v_cmp_gt_u32 vcc, 8, v2
    s_and_saveexec_b64 s[36:37], vcc
    global_store_dword v7, v66, s[88:89] sc1
    s_mov_b64 exec, s[36:37]
L_nostat:
    ds_read_b64_tr_b16 v[104:105], v10 offset:0
    ds_read_b64_tr_b16 v[106:107], v10 offset:1024
    ds_read_b64_tr_b16 v[108:109], v10 offset:8192
    ds_read_b64_tr_b16 v[110:111], v10 offset:9216
    s_lshl_b32 s33, s30, 5
    s_add_u32 s33, s33, s20
    s_lshl_b32 s33, s33, 12
    s_add_u32 s33, s33, 2097152
    v_lshrrev_b32 v5, 5, v2
    v_lshlrev_b32 v5, 6, v5
    v_and_b32 v6, 7, v2
    v_lshl_add_u32 v5, v6, 2, v5
    v_bfe_u32 v6, v2, 3, 2
    v_add_u32 v5, v5, v6
    v_lshlrev_b32 v5, 2, v5
    s_lshr_b32 s34, s22, 2
    s_lshl_b32 s34, s34, 10
    s_and_b32 s35, s22, 1
    s_lshl_b32 s35, s35, 9
    s_add_u32 s34, s34, s35
    s_bfe_u32 s35, s22, 0x10001
    s_lshl_b32 s35, s35, 7
    s_add_u32 s34, s34, s35
    s_add_u32 s34, s34, s33
    v_add_u32 v5, s34, v5
    s_lshr_b32 s34, s22, 1
    s_lshl_b32 s34, s34, 3
    s_add_u32 s34, s34, s33
    s_add_u32 s34, s34, 2048
    v_mov_b32 v6, s34
    v_add_u32 v69, 32768, v5
    v_add_u32 v73, 32768, v6
    v_add_u32 v70, 65536, v5
    v_add_u32 v74, 65536, v6
    v_add_u32 v71, 98304, v5
    v_add_u32 v75, 98304, v6
    v_mov_b32 v68, v5
    v_mov_b32 v72, v6
    s_mov_b32 s96, 0
L_lw3:
    ds_read_b32 v123, v125 offset:12
    s_waitcnt lgkmcnt(0)
    v_cmp_gt_u32 vcc, 1, v123
    s_cbranch_vccz L_lw3_d
    s_sleep 1
    s_add_u32 s96, s96, 1
    s_cmp_lt_u32 s96, 4000
    s_cbranch_scc1 L_lw3
L_lw3_d:
    s_mov_b32 s96, 0
L_po:
    global_load_dword v48, v68, s[88:89] sc1
    global_load_dword v49, v69, s[88:89] sc1
    global_load_dword v50, v70, s[88:89] sc1
    global_load_dword v51, v71, s[88:89] sc1
    global_load_dwordx2 v[76:77], v72, s[88:89] sc1
    global_load_dwordx2 v[78:79], v73, s[88:89] sc1
    global_load_dwordx2 v[80:81], v74, s[88:89] sc1
    global_load_dwordx2 v[82:83], v75, s[88:89] sc1
    s_waitcnt vmcnt(0)
    v_cmp_eq_u32 s[38:39], -1, v48
    v_cmp_eq_u32 vcc, -1, v49
    s_or_b64 s[38:39], s[38:39], vcc
    v_cmp_eq_u32 vcc, -1, v50
    s_or_b64 s[38:39], s[38:39], vcc
    v_cmp_eq_u32 vcc, -1, v51
    s_or_b64 s[38:39], s[38:39], vcc
    v_cmp_eq_u32 vcc, -1, v76
    s_or_b64 s[38:39], s[38:39], vcc
    v_cmp_eq_u32 vcc, -1, v77
    s_or_b64 s[38:39], s[38:39], vcc
    v_cmp_eq_u32 vcc, -1, v78
    s_or_b64 s[38:39], s[38:39], vcc
    v_cmp_eq_u32 vcc, -1, v79
    s_or_b64 s[38:39], s[38:39], vcc
    v_cmp_eq_u32 vcc, -1, v80
    s_or_b64 s[38:39], s[38:39], vcc
    v_cmp_eq_u32 vcc, -1, v81
    s_or_b64 s[38:39], s[38:39], vcc
    v_cmp_eq_u32 vcc, -1, v82
    s_or_b64 s[38:39], s[38:39], vcc
    v_cmp_eq_u32 vcc, -1, v83
    s_or_b64 s[38:39], s[38:39], vcc
    s_mov_b64 vcc, s[38:39]
    s_cbranch_vccz L_po_done
    s_add_u32 s96, s96, 1
    s_cmp_lt_u32 s96, 4000
    s_cbranch_scc1 L_po
L_po_done:
    v_max3_f32 v8, v76, v78, v80
    v_max_f32 v8, v8, v82
    v_sub_f32 v76, v76, v8
    v_mul_f32 v76, 0x3fb8aa3b, v76
    v_exp_f32 v76, v76
    v_sub_f32 v78, v78, v8
    v_mul_f32 v78, 0x3fb8aa3b, v78
    v_exp_f32 v78, v78
    v_sub_f32 v80, v80, v8
    v_mul_f32 v80, 0x3fb8aa3b, v80
    v_exp_f32 v80, v80
    v_sub_f32 v82, v82, v8
    v_mul_f32 v82, 0x3fb8aa3b, v82
    v_exp_f32 v82, v82
    s_nop 0
    v_mul_f32 v9, v76, v77
    v_fmac_f32 v9, v78, v79
    v_fmac_f32 v9, v80, v81
    v_fmac_f32 v9, v82, v83
    v_rcp_f32 v9, v9
    v_mul_f32 v48, v48, v76
    v_fmac_f32 v48, v49, v78
    v_fmac_f32 v48, v50, v80
    v_fmac_f32 v48, v51, v82
    v_mul_f32 v48, v48, v9
    v_cvt_pk_bf16_f32 v48, v48, v48
    s_mul_i32 s33, s30, 144
    s_add_u32 s33, s33, 133504
    v_lshlrev_b32 v6, 1, v2
    v_add_u32 v6, s33, v6
    ds_write_b16 v6, v48
    v_and_b32 v6, 7, v3
    v_mul_u32_u24 v6, 144, v6
    v_lshl_add_u32 v6, v4, 4, v6
    v_add_u32 v6, 133504, v6
    v_mov_b32 v56, 0
    v_mov_b32 v57, 0
    v_mov_b32 v58, 0
    v_mov_b32 v59, 0
    s_lshl_b32 s33, s30, 9
    s_add_u32 s33, s33, 81920
    v_lshlrev_b32 v7, 8, v4
    v_lshl_add_u32 v7, v3, 2, v7
    v_add_u32 v7, s33, v7
    v_lshlrev_b32 v8, 4, v2
    v_add_u32 v8, s33, v8
    v_lshrrev_b32 v5, 2, v2
    v_lshlrev_b32 v5, 9, v5
    v_and_b32 v9, 3, v2
    v_lshl_add_u32 v5, v9, 4, v5
    s_lshl_b32 s33, s2, 12
    s_lshl_b32 s34, s30, 6
    s_add_u32 s33, s33, s34
    s_add_u32 s33, s33, 4194304
    v_add_u32 v5, s33, v5
    s_waitcnt lgkmcnt(0)
    v_mov_b32 v123, 1
    s_mov_b64 s[36:37], exec
    s_mov_b64 exec, 1
    ds_add_u32 v125, v123 offset:8
    s_mov_b64 exec, s[36:37]
    s_mov_b32 s96, 0
L_lw4:
    ds_read_b32 v123, v125 offset:8
    s_waitcnt lgkmcnt(0)
    v_cmp_gt_u32 vcc, 16, v123
    s_cbranch_vccz L_lw4_d
    s_sleep 1
    s_add_u32 s96, s96, 1
    s_cmp_lt_u32 s96, 4000
    s_cbranch_scc1 L_lw4
L_lw4_d:
    ds_read_b128 v[48:51], v6
    ds_read_b128 v[52:55], v6 offset:64
    s_waitcnt lgkmcnt(0)
    v_mfma_f32_16x16x32_bf16 v[56:59], v[48:51], v[104:107], v[56:59]
    v_mfma_f32_16x16x32_bf16 v[56:59], v[52:55], v[108:111], v[56:59]
    s_nop 9
    v_cmp_eq_u32 vcc, -1, v56
    s_nop 1
    v_cndmask_b32 v56, v56, v124, vcc
    v_cmp_eq_u32 vcc, -1, v57
    s_nop 1
    v_cndmask_b32 v57, v57, v124, vcc
    v_cmp_eq_u32 vcc, -1, v58
    s_nop 1
    v_cndmask_b32 v58, v58, v124, vcc
    v_cmp_eq_u32 vcc, -1, v59
    s_nop 1
    v_cndmask_b32 v59, v59, v124, vcc
    v_cmp_gt_u32 vcc, 32, v2
    s_and_saveexec_b64 s[36:37], vcc
    ds_write_b32 v7, v56 offset:0
    ds_write_b32 v7, v57 offset:64
    ds_write_b32 v7, v58 offset:128
    ds_write_b32 v7, v59 offset:192
    ds_read_b128 v[60:63], v8
    s_waitcnt lgkmcnt(0)
    global_store_dwordx4 v5, v[60:63], s[88:89] sc1
    s_endpgm
L_ctrl:
    s_sub_u32 s31, s30, 8
    s_cmp_lg_u32 s30, 8
    s_cbranch_scc1 L_n0
    s_cmp_lg_u32 s2, 0
    s_cbranch_scc1 L_n0
    s_memrealtime s[96:97]
    s_waitcnt lgkmcnt(0)
    s_or_b32 s96, s96, 1
    v_mov_b32 v12, s96
    v_mov_b32 v13, 0
    s_mov_b64 exec, 1
    global_store_dword v13, v12, s[86:87] sc1
    s_mov_b64 exec, -1
L_n0:
    s_mov_b32 s40, s70
    s_mov_b32 s41, s71
    s_mov_b32 s42, 0x400000
    s_mov_b32 s43, 0x20000
    s_mov_b32 s48, s76
    s_mov_b32 s49, s77
    s_mov_b32 s50, 0x1c0000
    s_mov_b32 s51, 0x20000
    v_lshrrev_b32 v5, 5, v2
    v_and_b32 v6, 31, v2
    s_lshl_b32 s32, s31, 1
    v_add_u32 v7, s32, v5
    v_lshlrev_b32 v8, 10, v7
    v_lshl_add_u32 v8, v6, 5, v8
    global_load_dwordx4 v[40:43], v8, s[64:65]
    global_load_dwordx4 v[44:47], v8, s[64:65] offset:16
    s_lshr_b32 s26, s21, 3
    s_and_b32 s27, s21, 7
    s_lshl_b32 s28, s20, 3
    s_add_u32 s27, s27, s28
    v_lshrrev_b32 v9, 3, v2
    v_and_b32 v10, 7, v2
    v_lshlrev_b32 v11, 13, v9
    v_lshl_add_u32 v11, v10, 4, v11
    s_lshl_b32 s32, s26, 7
    s_lshl_b32 s33, s31, 5
    s_add_u32 s32, s32, s33
    s_lshl_b32 s32, s32, 13
    s_lshl_b32 s33, s27, 7
    s_add_u32 s32, s32, s33
    s_lshl_b32 s34, s31, 12
    s_add_u32 s35, s34, 65536
    s_add_u32 m0, s35, 0
    s_add_u32 s33, s32, 0
    buffer_load_dwordx4 v11, s[40:43], s33 offen nt lds
    s_add_u32 m0, s35, 1024
    s_add_u32 s33, s32, 65536
    buffer_load_dwordx4 v11, s[40:43], s33 offen nt lds
    s_add_u32 m0, s35, 2048
    s_add_u32 s33, s32, 131072
    buffer_load_dwordx4 v11, s[40:43], s33 offen nt lds
    s_add_u32 m0, s35, 3072
    s_add_u32 s33, s32, 196608
    buffer_load_dwordx4 v11, s[40:43], s33 offen nt lds
    s_mul_i32 s28, s20, 14
    s_add_u32 s28, s28, s21
    s_lshr_b32 s29, s28, 2
    s_and_b32 s28, s28, 3
    s_cmp_ge_u32 s21, 14
    s_cbranch_scc1 L_now1
    v_mul_u32_u24 v11, 3584, v9
    v_lshl_add_u32 v11, v10, 4, v11
    s_lshl_b32 s32, s28, 7
    s_lshl_b32 s33, s31, 5
    s_add_u32 s32, s32, s33
    s_mul_i32 s32, s32, 3584
    s_lshl_b32 s33, s29, 7
    s_add_u32 s32, s32, s33
    s_add_u32 s35, s34, 81920
    s_add_u32 m0, s35, 0
    s_add_u32 s33, s32, 0
    buffer_load_dwordx4 v11, s[48:51], s33 offen nt lds
    s_add_u32 m0, s35, 1024
    s_add_u32 s33, s32, 28672
    buffer_load_dwordx4 v11, s[48:51], s33 offen nt lds
    s_add_u32 m0, s35, 2048
    s_add_u32 s33, s32, 57344
    buffer_load_dwordx4 v11, s[48:51], s33 offen nt lds
    s_add_u32 m0, s35, 3072
    s_add_u32 s33, s32, 86016
    buffer_load_dwordx4 v11, s[48:51], s33 offen nt lds
L_now1:
    v_mov_b32 v60, 0
    global_load_dword v61, v60, s[86:87] sc1
    v_mov_b32 v12, -1
    v_mov_b32 v13, -1
    v_mov_b32 v14, -1
    v_mov_b32 v15, -1
    v_lshlrev_b32 v16, 4, v2
    s_cmp_eq_u32 s31, 0
    s_cbranch_scc0 L_cl1
    s_lshl_b32 s32, s2, 12
    s_add_u32 s32, s32, 2097152
    v_add_u32 v17, s32, v16
    global_store_dwordx4 v17, v[12:15], s[88:89] sc1
    global_store_dwordx4 v17, v[12:15], s[88:89] offset:1024 sc1
    s_mov_b64 exec, 0xf
    global_store_dwordx4 v17, v[12:15], s[88:89] offset:2048 sc1
    s_mov_b64 exec, -1
    s_branch L_cldone
L_cl1:
    s_cmp_eq_u32 s31, 3
    s_cbranch_scc1 L_cl3
    s_lshl_b32 s32, s2, 12
    s_sub_u32 s33, s31, 1
    s_lshl_b32 s33, s33, 11
    s_add_u32 s32, s32, s33
    s_add_u32 s32, s32, 4194304
    v_add_u32 v17, s32, v16
    global_store_dwordx4 v17, v[12:15], s[88:89] sc1
    global_store_dwordx4 v17, v[12:15], s[88:89] offset:1024 sc1
    s_branch L_cldone
L_cl3:
    s_lshl_b32 s32, s2, 11
    s_add_u32 s32, s32, 6291456
    v_add_u32 v17, s32, v16
    global_store_dwordx4 v17, v[12:15], s[88:89] sc1
    global_store_dwordx4 v17, v[12:15], s[88:89] offset:1024 sc1
L_cldone:
    v_mov_b32 v12, 0
    v_mov_b32 v13, 0
    v_mov_b32 v14, 0
    v_mov_b32 v15, 0
    v_lshrrev_b32 v17, 5, v2
    s_lshl_b32 s32, s31, 1
    v_add_u32 v17, s32, v17
    v_lshlrev_b32 v17, 15, v17
    v_and_b32 v18, 31, v2
    v_lshl_add_u32 v17, v18, 4, v17
    s_lshl_b32 s32, s26, 18
    s_lshl_b32 s33, s27, 9
    s_add_u32 s32, s32, s33
    s_add_u32 s32, s32, 0
    v_add_u32 v19, s32, v17
    global_store_dwordx4 v19, v[12:15], s[88:89] sc1
    s_cmp_ge_u32 s21, 14
    s_cbranch_scc1 L_pt2
    v_lshrrev_b32 v17, 5, v2
    s_lshl_b32 s32, s31, 1
    v_add_u32 v17, s32, v17
    v_mul_u32_u24 v17, 14336, v17
    v_lshl_add_u32 v17, v18, 4, v17
    s_mul_i32 s32, s28, 114688
    s_lshl_b32 s33, s29, 9
    s_add_u32 s32, s32, s33
    s_add_u32 s32, s32, 1048576
    v_add_u32 v19, s32, v17
    global_store_dwordx4 v19, v[12:15], s[88:89] sc1
L_pt2:
    s_cmp_lg_u32 s31, 0
    s_cbranch_scc1 L_n1
    ds_write_b128 v125, v[12:15]
    ds_write_b128 v125, v[12:15] offset:16
L_n1:
    s_waitcnt lgkmcnt(0)
    s_barrier
    s_waitcnt vmcnt(0)
    v_lshlrev_b32 v16, 16, v40
    v_and_b32 v17, 0xffff0000, v40
    v_lshlrev_b32 v18, 16, v41
    v_and_b32 v19, 0xffff0000, v41
    v_lshlrev_b32 v20, 16, v42
    v_and_b32 v21, 0xffff0000, v42
    v_lshlrev_b32 v22, 16, v43
    v_and_b32 v23, 0xffff0000, v43
    v_lshlrev_b32 v24, 16, v44
    v_and_b32 v25, 0xffff0000, v44
    v_lshlrev_b32 v26, 16, v45
    v_and_b32 v27, 0xffff0000, v45
    v_lshlrev_b32 v28, 16, v46
    v_and_b32 v29, 0xffff0000, v46
    v_lshlrev_b32 v30, 16, v47
    v_and_b32 v31, 0xffff0000, v47
    v_add_f32 v32, v16, v17
    v_add_f32 v32, v32, v18
    v_add_f32 v32, v32, v19
    v_add_f32 v32, v32, v20
    v_add_f32 v32, v32, v21
    v_add_f32 v32, v32, v22
    v_add_f32 v32, v32, v23
    v_add_f32 v32, v32, v24
    v_add_f32 v32, v32, v25
    v_add_f32 v32, v32, v26
    v_add_f32 v32, v32, v27
    v_add_f32 v32, v32, v28
    v_add_f32 v32, v32, v29
    v_add_f32 v32, v32, v30
    v_add_f32 v32, v32, v31
    s_nop 1
    v_add_f32_dpp v32, v32, v32 quad_perm:[1,0,3,2] row_mask:0xf bank_mask:0xf
    s_nop 1
    v_add_f32_dpp v32, v32, v32 quad_perm:[2,3,0,1] row_mask:0xf bank_mask:0xf
    s_nop 1
    v_add_f32_dpp v32, v32, v32 row_half_mirror row_mask:0xf bank_mask:0xf
    s_nop 1
    v_add_f32_dpp v32, v32, v32 row_mirror row_mask:0xf bank_mask:0xf
    v_mov_b32 v33, v32
    s_nop 1
    v_permlane16_swap_b32 v32, v33
    s_nop 0
    v_add_f32 v32, v32, v33
    v_mul_f32 v32, 0x3b000000, v32
    v_sub_f32 v34, v16, v32
    v_mul_f32 v33, v34, v34
    v_sub_f32 v34, v17, v32
    v_fmac_f32 v33, v34, v34
    v_sub_f32 v34, v18, v32
    v_fmac_f32 v33, v34, v34
    v_sub_f32 v34, v19, v32
    v_fmac_f32 v33, v34, v34
    v_sub_f32 v34, v20, v32
    v_fmac_f32 v33, v34, v34
    v_sub_f32 v34, v21, v32
    v_fmac_f32 v33, v34, v34
    v_sub_f32 v34, v22, v32
    v_fmac_f32 v33, v34, v34
    v_sub_f32 v34, v23, v32
    v_fmac_f32 v33, v34, v34
    v_sub_f32 v34, v24, v32
    v_fmac_f32 v33, v34, v34
    v_sub_f32 v34, v25, v32
    v_fmac_f32 v33, v34, v34
    v_sub_f32 v34, v26, v32
    v_fmac_f32 v33, v34, v34
    v_sub_f32 v34, v27, v32
    v_fmac_f32 v33, v34, v34
    v_sub_f32 v34, v28, v32
    v_fmac_f32 v33, v34, v34
    v_sub_f32 v34, v29, v32
    v_fmac_f32 v33, v34, v34
    v_sub_f32 v34, v30, v32
    v_fmac_f32 v33, v34, v34
    v_sub_f32 v34, v31, v32
    v_fmac_f32 v33, v34, v34
    s_nop 1
    v_add_f32_dpp v33, v33, v33 quad_perm:[1,0,3,2] row_mask:0xf bank_mask:0xf
    s_nop 1
    v_add_f32_dpp v33, v33, v33 quad_perm:[2,3,0,1] row_mask:0xf bank_mask:0xf
    s_nop 1
    v_add_f32_dpp v33, v33, v33 row_half_mirror row_mask:0xf bank_mask:0xf
    s_nop 1
    v_add_f32_dpp v33, v33, v33 row_mirror row_mask:0xf bank_mask:0xf
    v_mov_b32 v34, v33
    s_nop 1
    v_permlane16_swap_b32 v33, v34
    s_nop 0
    v_add_f32 v33, v33, v34
    v_mul_f32 v33, 0x3b000000, v33
    v_cvt_pk_bf16_f32 v32, v32, v32
    v_lshlrev_b32 v32, 16, v32
    v_cvt_pk_bf16_f32 v33, v33, v33
    v_lshlrev_b32 v33, 16, v33
    v_add_f32 v33, 0x3727c5ac, v33
    v_cvt_pk_bf16_f32 v33, v33, v33
    v_lshlrev_b32 v33, 16, v33
    v_sqrt_f32 v33, v33
    s_nop 0
    v_cvt_pk_bf16_f32 v33, v33, v33
    v_lshlrev_b32 v33, 16, v33
    v_rcp_f32 v33, v33
    s_nop 0
    v_sub_f32 v16, v16, v32
    v_sub_f32 v17, v17, v32
    v_cvt_pk_bf16_f32 v34, v16, v17
    v_lshlrev_b32 v16, 16, v34
    v_and_b32 v17, 0xffff0000, v34
    v_mul_f32 v16, v16, v33
    v_mul_f32 v17, v17, v33
    v_cvt_pk_bf16_f32 v40, v16, v17
    v_sub_f32 v18, v18, v32
    v_sub_f32 v19, v19, v32
    v_cvt_pk_bf16_f32 v34, v18, v19
    v_lshlrev_b32 v18, 16, v34
    v_and_b32 v19, 0xffff0000, v34
    v_mul_f32 v18, v18, v33
    v_mul_f32 v19, v19, v33
    v_cvt_pk_bf16_f32 v41, v18, v19
    v_sub_f32 v20, v20, v32
    v_sub_f32 v21, v21, v32
    v_cvt_pk_bf16_f32 v34, v20, v21
    v_lshlrev_b32 v20, 16, v34
    v_and_b32 v21, 0xffff0000, v34
    v_mul_f32 v20, v20, v33
    v_mul_f32 v21, v21, v33
    v_cvt_pk_bf16_f32 v42, v20, v21
    v_sub_f32 v22, v22, v32
    v_sub_f32 v23, v23, v32
    v_cvt_pk_bf16_f32 v34, v22, v23
    v_lshlrev_b32 v22, 16, v34
    v_and_b32 v23, 0xffff0000, v34
    v_mul_f32 v22, v22, v33
    v_mul_f32 v23, v23, v33
    v_cvt_pk_bf16_f32 v43, v22, v23
    v_sub_f32 v24, v24, v32
    v_sub_f32 v25, v25, v32
    v_cvt_pk_bf16_f32 v34, v24, v25
    v_lshlrev_b32 v24, 16, v34
    v_and_b32 v25, 0xffff0000, v34
    v_mul_f32 v24, v24, v33
    v_mul_f32 v25, v25, v33
    v_cvt_pk_bf16_f32 v44, v24, v25
    v_sub_f32 v26, v26, v32
    v_sub_f32 v27, v27, v32
    v_cvt_pk_bf16_f32 v34, v26, v27
    v_lshlrev_b32 v26, 16, v34
    v_and_b32 v27, 0xffff0000, v34
    v_mul_f32 v26, v26, v33
    v_mul_f32 v27, v27, v33
    v_cvt_pk_bf16_f32 v45, v26, v27
    v_sub_f32 v28, v28, v32
    v_sub_f32 v29, v29, v32
    v_cvt_pk_bf16_f32 v34, v28, v29
    v_lshlrev_b32 v28, 16, v34
    v_and_b32 v29, 0xffff0000, v34
    v_mul_f32 v28, v28, v33
    v_mul_f32 v29, v29, v33
    v_cvt_pk_bf16_f32 v46, v28, v29
    v_sub_f32 v30, v30, v32
    v_sub_f32 v31, v31, v32
    v_cvt_pk_bf16_f32 v34, v30, v31
    v_lshlrev_b32 v30, 16, v34
    v_and_b32 v31, 0xffff0000, v34
    v_mul_f32 v30, v30, v33
    v_mul_f32 v31, v31, v33
    v_cvt_pk_bf16_f32 v47, v30, v31
    v_mul_u32_u24 v8, 1040, v7
    v_lshl_add_u32 v8, v6, 5, v8
    v_add_u32 v8, 122880, v8
    ds_write_b128 v8, v[40:43]
    ds_write_b128 v8, v[44:47] offset:16
    v_mov_b32 v13, 0
    v_mov_b32 v12, v61
    v_cmp_ne_u32 vcc, 0, v12
    s_cbranch_vccnz L_pn_done
    s_mov_b32 s96, 0
L_pn:
    global_load_dword v12, v13, s[86:87] sc1
    s_waitcnt vmcnt(0)
    v_cmp_eq_u32 vcc, 0, v12
    s_cbranch_vccz L_pn_done
    s_sleep 1
    s_add_u32 s96, s96, 1
    s_cmp_lt_u32 s96, 4000
    s_cbranch_scc1 L_pn
L_pn_done:
    v_readfirstlane_b32 s95, v12
    s_waitcnt lgkmcnt(0)
    v_mov_b32 v123, 1
    s_mov_b64 s[36:37], exec
    s_mov_b64 exec, 1
    ds_add_u32 v125, v123 offset:0
    s_mov_b64 exec, s[36:37]
    s_mov_b32 s96, 0
L_lw5:
    ds_read_b32 v123, v125 offset:0
    s_waitcnt lgkmcnt(0)
    v_cmp_gt_u32 vcc, 4, v123
    s_cbranch_vccz L_lw5_d
    s_sleep 1
    s_add_u32 s96, s96, 1
    s_cmp_lt_u32 s96, 4000
    s_cbranch_scc1 L_lw5
L_lw5_d:
    s_cmp_lg_u32 s31, 3
    s_cbranch_scc1 L_nf
    v_mov_b32 v12, 1
    v_mov_b32 v13, s95
    s_lshl_b32 s32, s2, 3
    s_add_u32 s32, s32, 7340032
    v_mov_b32 v14, s32
    s_mov_b64 exec, 1
    global_store_dwordx2 v14, v[12:13], s[88:89] sc1
    s_mov_b64 exec, -1
L_nf:
    v_and_b32 v5, 7, v3
    v_mul_u32_u24 v5, 1040, v5
    v_lshl_add_u32 v5, v4, 4, v5
    s_lshl_b32 s32, s26, 8
    s_add_u32 s32, s32, 122880
    v_add_u32 v5, s32, v5
    ds_read_b128 v[16:19], v5 offset:0
    ds_read_b128 v[20:23], v5 offset:64
    ds_read_b128 v[24:27], v5 offset:128
    ds_read_b128 v[28:31], v5 offset:192
    v_lshrrev_b32 v6, 2, v3
    v_lshl_add_u32 v6, v4, 3, v6
    v_lshlrev_b32 v6, 7, v6
    v_and_b32 v7, 3, v3
    v_lshl_add_u32 v6, v7, 3, v6
    s_lshl_b32 s32, s31, 5
    s_add_u32 s32, s32, 65536
    v_add_u32 v6, s32, v6
    ds_read_b64_tr_b16 v[32:33], v6 offset:0
    ds_read_b64_tr_b16 v[34:35], v6 offset:512
    ds_read_b64_tr_b16 v[36:37], v6 offset:4096
    ds_read_b64_tr_b16 v[38:39], v6 offset:4608
    ds_read_b64_tr_b16 v[40:41], v6 offset:8192
    ds_read_b64_tr_b16 v[42:43], v6 offset:8704
    ds_read_b64_tr_b16 v[44:45], v6 offset:12288
    ds_read_b64_tr_b16 v[46:47], v6 offset:12800
    v_mov_b32 v48, 0
    v_mov_b32 v49, 0
    v_mov_b32 v50, 0
    v_mov_b32 v51, 0
    v_mov_b32 v53, s95
    v_mov_b32 v55, s95
    v_mov_b32 v57, s95
    v_mov_b32 v59, s95
    v_mul_u32_u24 v7, 131072, v4
    v_lshl_add_u32 v7, v3, 3, v7
    s_mul_i32 s32, s26, 262144
    s_lshl_b32 s33, s27, 9
    s_add_u32 s32, s32, s33
    s_lshl_b32 s33, s31, 7
    s_add_u32 s32, s32, s33
    s_add_u32 s32, s32, 0
    v_add_u32 v7, s32, v7
    s_waitcnt lgkmcnt(0)
    v_mfma_f32_16x16x32_bf16 v[48:51], v[16:19], v[32:35], v[48:51]
    v_mfma_f32_16x16x32_bf16 v[48:51], v[20:23], v[36:39], v[48:51]
    v_mfma_f32_16x16x32_bf16 v[48:51], v[24:27], v[40:43], v[48:51]
    v_mfma_f32_16x16x32_bf16 v[48:51], v[28:31], v[44:47], v[48:51]
    s_nop 9
    v_mov_b32 v52, v48
    v_mov_b32 v54, v49
    v_mov_b32 v56, v50
    v_mov_b32 v58, v51
    v_cmp_gt_u32 vcc, 32, v2
    s_and_saveexec_b64 s[36:37], vcc
    v_add_u32 v8, 0, v7
    global_store_dwordx2 v8, v[52:53], s[88:89] sc1
    v_add_u32 v8, 32768, v7
    global_store_dwordx2 v8, v[54:55], s[88:89] sc1
    v_add_u32 v8, 65536, v7
    global_store_dwordx2 v8, v[56:57], s[88:89] sc1
    v_add_u32 v8, 98304, v7
    global_store_dwordx2 v8, v[58:59], s[88:89] sc1
    s_mov_b64 exec, s[36:37]
    s_cmp_ge_u32 s21, 14
    s_cbranch_scc1 L_noh
    v_and_b32 v5, 7, v3
    v_mul_u32_u24 v5, 1040, v5
    v_lshl_add_u32 v5, v4, 4, v5
    s_lshl_b32 s32, s28, 8
    s_add_u32 s32, s32, 122880
    v_add_u32 v5, s32, v5
    ds_read_b128 v[16:19], v5 offset:0
    ds_read_b128 v[20:23], v5 offset:64
    ds_read_b128 v[24:27], v5 offset:128
    ds_read_b128 v[28:31], v5 offset:192
    v_lshrrev_b32 v6, 2, v3
    v_lshl_add_u32 v6, v4, 3, v6
    v_lshlrev_b32 v6, 7, v6
    v_and_b32 v7, 3, v3
    v_lshl_add_u32 v6, v7, 3, v6
    s_lshl_b32 s32, s31, 5
    s_add_u32 s32, s32, 81920
    v_add_u32 v6, s32, v6
    ds_read_b64_tr_b16 v[32:33], v6 offset:0
    ds_read_b64_tr_b16 v[34:35], v6 offset:512
    ds_read_b64_tr_b16 v[36:37], v6 offset:4096
    ds_read_b64_tr_b16 v[38:39], v6 offset:4608
    ds_read_b64_tr_b16 v[40:41], v6 offset:8192
    ds_read_b64_tr_b16 v[42:43], v6 offset:8704
    ds_read_b64_tr_b16 v[44:45], v6 offset:12288
    ds_read_b64_tr_b16 v[46:47], v6 offset:12800
    v_mov_b32 v48, 0
    v_mov_b32 v49, 0
    v_mov_b32 v50, 0
    v_mov_b32 v51, 0
    v_mov_b32 v53, s95
    v_mov_b32 v55, s95
    v_mov_b32 v57, s95
    v_mov_b32 v59, s95
    v_mul_u32_u24 v7, 57344, v4
    v_lshl_add_u32 v7, v3, 3, v7
    s_mul_i32 s32, s28, 114688
    s_lshl_b32 s33, s29, 9
    s_add_u32 s32, s32, s33
    s_lshl_b32 s33, s31, 7
    s_add_u32 s32, s32, s33
    s_add_u32 s32, s32, 1048576
    v_add_u32 v7, s32, v7
    s_waitcnt lgkmcnt(0)
    v_mfma_f32_16x16x32_bf16 v[48:51], v[16:19], v[32:35], v[48:51]
    v_mfma_f32_16x16x32_bf16 v[48:51], v[20:23], v[36:39], v[48:51]
    v_mfma_f32_16x16x32_bf16 v[48:51], v[24:27], v[40:43], v[48:51]
    v_mfma_f32_16x16x32_bf16 v[48:51], v[28:31], v[44:47], v[48:51]
    s_nop 9
    v_mov_b32 v52, v48
    v_mov_b32 v54, v49
    v_mov_b32 v56, v50
    v_mov_b32 v58, v51
    v_cmp_gt_u32 vcc, 32, v2
    s_and_saveexec_b64 s[36:37], vcc
    v_add_u32 v8, 0, v7
    global_store_dwordx2 v8, v[52:53], s[88:89] sc1
    v_add_u32 v8, 14336, v7
    global_store_dwordx2 v8, v[54:55], s[88:89] sc1
    v_add_u32 v8, 28672, v7
    global_store_dwordx2 v8, v[56:57], s[88:89] sc1
    v_add_u32 v8, 43008, v7
    global_store_dwordx2 v8, v[58:59], s[88:89] sc1
    s_mov_b64 exec, s[36:37]
L_noh:
    s_cmp_ge_u32 s31, 2
    s_cbranch_scc1 L_sph
    v_and_b32 v5, 31, v2
    v_lshrrev_b32 v6, 3, v5
    v_and_b32 v7, 7, v5
    v_lshlrev_b32 v6, 18, v6
    v_lshl_add_u32 v6, v7, 9, v6
    s_lshl_b32 s32, s22, 15
    s_lshl_b32 s33, s20, 12
    s_add_u32 s32, s32, s33
    s_add_u32 s32, s32, 0
    s_lshl_b32 s33, s31, 8
    s_add_u32 s33, s33, s32
    s_add_u32 s33, s33, 248
    v_add_u32 v6, s33, v6
    s_mov_b32 s96, 0
L_sq:
    global_load_dwordx2 v[16:17], v6, s[88:89] sc1
    s_waitcnt vmcnt(0)
    v_cmp_ne_u32 vcc, s95, v17
    s_cbranch_vccz L_sq_done
    s_sleep 2
    s_add_u32 s96, s96, 1
    s_cmp_lt_u32 s96, 4000
    s_cbranch_scc1 L_sq
L_sq_done:
    s_lshl_b32 s33, s31, 6
    v_add_u32 v5, s33, v2
    v_lshlrev_b32 v6, 5, v5
    v_add_u32 v6, s32, v6
    v_add_u32 v9, 262144, v6
    v_add_u32 v10, 524288, v6
    v_add_u32 v11, 786432, v6
    v_mov_b32 v8, v6
    s_mov_b32 s96, 0
L_pq:
    global_load_dwordx4 v[16:19], v8, s[88:89] sc1
    global_load_dwordx4 v[20:23], v8, s[88:89] offset:16 sc1
    global_load_dwordx4 v[24:27], v9, s[88:89] sc1
    global_load_dwordx4 v[28:31], v9, s[88:89] offset:16 sc1
    global_load_dwordx4 v[32:35], v10, s[88:89] sc1
    global_load_dwordx4 v[36:39], v10, s[88:89] offset:16 sc1
    global_load_dwordx4 v[40:43], v11, s[88:89] sc1
    global_load_dwordx4 v[44:47], v11, s[88:89] offset:16 sc1
    s_waitcnt vmcnt(0)
    v_cmp_ne_u32 s[38:39], s95, v17
    v_cmp_ne_u32 vcc, s95, v19
    s_or_b64 s[38:39], s[38:39], vcc
    v_cmp_ne_u32 vcc, s95, v21
    s_or_b64 s[38:39], s[38:39], vcc
    v_cmp_ne_u32 vcc, s95, v23
    s_or_b64 s[38:39], s[38:39], vcc
    v_cmp_ne_u32 vcc, s95, v25
    s_or_b64 s[38:39], s[38:39], vcc
    v_cmp_ne_u32 vcc, s95, v27
    s_or_b64 s[38:39], s[38:39], vcc
    v_cmp_ne_u32 vcc, s95, v29
    s_or_b64 s[38:39], s[38:39], vcc
    v_cmp_ne_u32 vcc, s95, v31
    s_or_b64 s[38:39], s[38:39], vcc
    v_cmp_ne_u32 vcc, s95, v33
    s_or_b64 s[38:39], s[38:39], vcc
    v_cmp_ne_u32 vcc, s95, v35
    s_or_b64 s[38:39], s[38:39], vcc
    v_cmp_ne_u32 vcc, s95, v37
    s_or_b64 s[38:39], s[38:39], vcc
    v_cmp_ne_u32 vcc, s95, v39
    s_or_b64 s[38:39], s[38:39], vcc
    v_cmp_ne_u32 vcc, s95, v41
    s_or_b64 s[38:39], s[38:39], vcc
    v_cmp_ne_u32 vcc, s95, v43
    s_or_b64 s[38:39], s[38:39], vcc
    v_cmp_ne_u32 vcc, s95, v45
    s_or_b64 s[38:39], s[38:39], vcc
    v_cmp_ne_u32 vcc, s95, v47
    s_or_b64 s[38:39], s[38:39], vcc
    s_mov_b64 vcc, s[38:39]
    s_cbranch_vccz L_pq_done
    s_sleep 2
    s_add_u32 s96, s96, 1
    s_cmp_lt_u32 s96, 4000
    s_cbranch_scc1 L_pq
L_pq_done:
    v_add_f32 v16, v16, v24
    v_add_f32 v32, v32, v40
    v_add_f32 v16, v16, v32
    v_add_f32 v18, v18, v26
    v_add_f32 v34, v34, v42
    v_add_f32 v18, v18, v34
    v_add_f32 v20, v20, v28
    v_add_f32 v36, v36, v44
    v_add_f32 v20, v20, v36
    v_add_f32 v22, v22, v30
    v_add_f32 v38, v38, v46
    v_add_f32 v22, v22, v38
    v_cvt_pk_bf16_f32 v24, v16, v18
    v_cvt_pk_bf16_f32 v25, v20, v22
    v_lshlrev_b32 v6, 3, v5
    v_add_u32 v6, 131328, v6
    ds_write_b64 v6, v[24:25]
    s_waitcnt lgkmcnt(0)
    v_mov_b32 v123, 1
    s_mov_b64 s[36:37], exec
    s_mov_b64 exec, 1
    ds_add_u32 v125, v123 offset:24
    s_mov_b64 exec, s[36:37]
L_sph:
    s_mov_b32 s96, 0
L_lw6:
    ds_read_b32 v123, v125 offset:24
    s_waitcnt lgkmcnt(0)
    v_cmp_gt_u32 vcc, 2, v123
    s_cbranch_vccz L_lw6_d
    s_sleep 1
    s_add_u32 s96, s96, 1
    s_cmp_lt_u32 s96, 4000
    s_cbranch_scc1 L_lw6
L_lw6_d:
    s_mov_b32 s96, 0
L_lw7:
    ds_read_b32 v123, v125 offset:16
    s_waitcnt lgkmcnt(0)
    v_cmp_gt_u32 vcc, 8, v123
    s_cbranch_vccz L_lw7_d
    s_sleep 1
    s_add_u32 s96, s96, 1
    s_cmp_lt_u32 s96, 4000
    s_cbranch_scc1 L_lw7
L_lw7_d:
    v_and_b32 v5, 3, v3
    v_lshlrev_b32 v5, 2, v5
    v_lshrrev_b32 v6, 2, v3
    v_or_b32 v5, v5, v6
    v_lshlrev_b32 v6, 8, v5
    s_lshl_b32 s32, s31, 14
    v_add_u32 v6, s32, v6
    v_add_u32 v7, 0, v4
    v_xor_b32 v7, v7, v5
    v_lshl_add_u32 v8, v7, 4, v6
    v_add_u32 v7, 4, v4
    v_xor_b32 v7, v7, v5
    v_lshl_add_u32 v9, v7, 4, v6
    v_add_u32 v7, 8, v4
    v_xor_b32 v7, v7, v5
    v_lshl_add_u32 v10, v7, 4, v6
    v_add_u32 v7, 12, v4
    v_xor_b32 v7, v7, v5
    v_lshl_add_u32 v11, v7, 4, v6
    ds_read_b128 v[16:19], v8 offset:0
    ds_read_b128 v[20:23], v9 offset:0
    ds_read_b128 v[24:27], v10 offset:0
    ds_read_b128 v[28:31], v11 offset:0
    ds_read_b128 v[32:35], v8 offset:4096
    ds_read_b128 v[36:39], v9 offset:4096
    ds_read_b128 v[40:43], v10 offset:4096
    ds_read_b128 v[44:47], v11 offset:4096
    ds_read_b128 v[48:51], v8 offset:8192
    ds_read_b128 v[52:55], v9 offset:8192
    ds_read_b128 v[56:59], v10 offset:8192
    ds_read_b128 v[60:63], v11 offset:8192
    ds_read_b128 v[64:67], v8 offset:12288
    ds_read_b128 v[68:71], v9 offset:12288
    ds_read_b128 v[72:75], v10 offset:12288
    ds_read_b128 v[76:79], v11 offset:12288
    v_and_b32 v7, 3, v3
    v_lshlrev_b32 v7, 8, v7
    v_lshl_add_u32 v7, v4, 4, v7
    v_add_u32 v7, 131328, v7
    ds_read_b128 v[80:83], v7 offset:0
    ds_read_b128 v[84:87], v7 offset:64
    ds_read_b128 v[88:91], v7 offset:128
    ds_read_b128 v[92:95], v7 offset:192
    v_mov_b32 v96, 0
    v_mov_b32 v97, 0
    v_mov_b32 v98, 0
    v_mov_b32 v99, 0
    v_mov_b32 v100, 0
    v_mov_b32 v101, 0
    v_mov_b32 v102, 0
    v_mov_b32 v103, 0
    v_mov_b32 v104, 0
    v_mov_b32 v105, 0
    v_mov_b32 v106, 0
    v_mov_b32 v107, 0
    v_mov_b32 v108, 0
    v_mov_b32 v109, 0
    v_mov_b32 v110, 0
    v_mov_b32 v111, 0
    s_waitcnt lgkmcnt(0)
    v_mfma_f32_16x16x32_bf16 v[96:99], v[16:19], v[80:83], v[96:99]
    v_mfma_f32_16x16x32_bf16 v[100:103], v[32:35], v[80:83], v[100:103]
    v_mfma_f32_16x16x32_bf16 v[104:107], v[48:51], v[80:83], v[104:107]
    v_mfma_f32_16x16x32_bf16 v[108:111], v[64:67], v[80:83], v[108:111]
    v_mfma_f32_16x16x32_bf16 v[96:99], v[20:23], v[84:87], v[96:99]
    v_mfma_f32_16x16x32_bf16 v[100:103], v[36:39], v[84:87], v[100:103]
    v_mfma_f32_16x16x32_bf16 v[104:107], v[52:55], v[84:87], v[104:107]
    v_mfma_f32_16x16x32_bf16 v[108:111], v[68:71], v[84:87], v[108:111]
    v_mfma_f32_16x16x32_bf16 v[96:99], v[24:27], v[88:91], v[96:99]
    v_mfma_f32_16x16x32_bf16 v[100:103], v[40:43], v[88:91], v[100:103]
    v_mfma_f32_16x16x32_bf16 v[104:107], v[56:59], v[88:91], v[104:107]
    v_mfma_f32_16x16x32_bf16 v[108:111], v[72:75], v[88:91], v[108:111]
    v_mfma_f32_16x16x32_bf16 v[96:99], v[28:31], v[92:95], v[96:99]
    v_mfma_f32_16x16x32_bf16 v[100:103], v[44:47], v[92:95], v[100:103]
    v_mfma_f32_16x16x32_bf16 v[104:107], v[60:63], v[92:95], v[104:107]
    v_mfma_f32_16x16x32_bf16 v[108:111], v[76:79], v[92:95], v[108:111]
    s_nop 9
    s_mov_b32 s34, 0x3db504f3
    v_cvt_pk_bf16_f32 v8, v96, v97
    v_lshlrev_b32 v96, 16, v8
    v_and_b32 v97, 0xffff0000, v8
    v_mul_f32 v96, s34, v96
    v_mul_f32 v97, s34, v97
    v_cvt_pk_bf16_f32 v8, v96, v97
    v_lshlrev_b32 v96, 16, v8
    v_and_b32 v97, 0xffff0000, v8
    v_cvt_pk_bf16_f32 v8, v98, v99
    v_lshlrev_b32 v98, 16, v8
    v_and_b32 v99, 0xffff0000, v8
    v_mul_f32 v98, s34, v98
    v_mul_f32 v99, s34, v99
    v_cvt_pk_bf16_f32 v8, v98, v99
    v_lshlrev_b32 v98, 16, v8
    v_and_b32 v99, 0xffff0000, v8
    v_cvt_pk_bf16_f32 v8, v100, v101
    v_lshlrev_b32 v100, 16, v8
    v_and_b32 v101, 0xffff0000, v8
    v_mul_f32 v100, s34, v100
    v_mul_f32 v101, s34, v101
    v_cvt_pk_bf16_f32 v8, v100, v101
    v_lshlrev_b32 v100, 16, v8
    v_and_b32 v101, 0xffff0000, v8
    v_cvt_pk_bf16_f32 v8, v102, v103
    v_lshlrev_b32 v102, 16, v8
    v_and_b32 v103, 0xffff0000, v8
    v_mul_f32 v102, s34, v102
    v_mul_f32 v103, s34, v103
    v_cvt_pk_bf16_f32 v8, v102, v103
    v_lshlrev_b32 v102, 16, v8
    v_and_b32 v103, 0xffff0000, v8
    v_cvt_pk_bf16_f32 v8, v104, v105
    v_lshlrev_b32 v104, 16, v8
    v_and_b32 v105, 0xffff0000, v8
    v_mul_f32 v104, s34, v104
    v_mul_f32 v105, s34, v105
    v_cvt_pk_bf16_f32 v8, v104, v105
    v_lshlrev_b32 v104, 16, v8
    v_and_b32 v105, 0xffff0000, v8
    v_cvt_pk_bf16_f32 v8, v106, v107
    v_lshlrev_b32 v106, 16, v8
    v_and_b32 v107, 0xffff0000, v8
    v_mul_f32 v106, s34, v106
    v_mul_f32 v107, s34, v107
    v_cvt_pk_bf16_f32 v8, v106, v107
    v_lshlrev_b32 v106, 16, v8
    v_and_b32 v107, 0xffff0000, v8
    v_cvt_pk_bf16_f32 v8, v108, v109
    v_lshlrev_b32 v108, 16, v8
    v_and_b32 v109, 0xffff0000, v8
    v_mul_f32 v108, s34, v108
    v_mul_f32 v109, s34, v109
    v_cvt_pk_bf16_f32 v8, v108, v109
    v_lshlrev_b32 v108, 16, v8
    v_and_b32 v109, 0xffff0000, v8
    v_cvt_pk_bf16_f32 v8, v110, v111
    v_lshlrev_b32 v110, 16, v8
    v_and_b32 v111, 0xffff0000, v8
    v_mul_f32 v110, s34, v110
    v_mul_f32 v111, s34, v111
    v_cvt_pk_bf16_f32 v8, v110, v111
    v_lshlrev_b32 v110, 16, v8
    v_and_b32 v111, 0xffff0000, v8
    v_max3_f32 v112, v96, v97, v98
    v_max3_f32 v112, v112, v99, v100
    v_max3_f32 v112, v112, v101, v102
    v_max3_f32 v112, v112, v103, v104
    v_max3_f32 v112, v112, v105, v106
    v_max3_f32 v112, v112, v107, v108
    v_max3_f32 v112, v112, v109, v110
    v_max_f32 v112, v112, v111
    v_mov_b32 v8, v112
    s_nop 1
    v_permlane16_swap_b32 v112, v8
    s_nop 0
    v_max_f32 v112, v112, v8
    v_mov_b32 v8, v112
    s_nop 1
    v_permlane32_swap_b32 v112, v8
    s_nop 0
    v_max_f32 v112, v112, v8
    v_and_b32 v7, 3, v3
    v_lshlrev_b32 v7, 4, v7
    s_lshl_b32 s33, s31, 2
    s_add_u32 s33, s33, 134656
    v_add_u32 v9, s33, v7
    ds_write_b32 v9, v112
    s_waitcnt lgkmcnt(0)
    v_mov_b32 v123, 1
    s_mov_b64 s[36:37], exec
    s_mov_b64 exec, 1
    ds_add_u32 v125, v123 offset:0
    s_mov_b64 exec, s[36:37]
    s_mov_b32 s96, 0
L_lw8:
    ds_read_b32 v123, v125 offset:0
    s_waitcnt lgkmcnt(0)
    v_cmp_gt_u32 vcc, 8, v123
    s_cbranch_vccz L_lw8_d
    s_sleep 1
    s_add_u32 s96, s96, 1
    s_cmp_lt_u32 s96, 4000
    s_cbranch_scc1 L_lw8
L_lw8_d:
    v_add_u32 v9, 134656, v7
    ds_read_b128 v[16:19], v9
    s_waitcnt lgkmcnt(0)
    v_max3_f32 v112, v16, v17, v18
    v_max_f32 v112, v112, v19
    s_mov_b32 s34, 0x3fb8aa3b
    v_sub_f32 v96, v96, v112
    v_mul_f32 v96, s34, v96
    v_exp_f32 v96, v96
    v_sub_f32 v97, v97, v112
    v_mul_f32 v97, s34, v97
    v_exp_f32 v97, v97
    v_sub_f32 v98, v98, v112
    v_mul_f32 v98, s34, v98
    v_exp_f32 v98, v98
    v_sub_f32 v99, v99, v112
    v_mul_f32 v99, s34, v99
    v_exp_f32 v99, v99
    v_sub_f32 v100, v100, v112
    v_mul_f32 v100, s34, v100
    v_exp_f32 v100, v100
    v_sub_f32 v101, v101, v112
    v_mul_f32 v101, s34, v101
    v_exp_f32 v101, v101
    v_sub_f32 v102, v102, v112
    v_mul_f32 v102, s34, v102
    v_exp_f32 v102, v102
    v_sub_f32 v103, v103, v112
    v_mul_f32 v103, s34, v103
    v_exp_f32 v103, v103
    v_sub_f32 v104, v104, v112
    v_mul_f32 v104, s34, v104
    v_exp_f32 v104, v104
    v_sub_f32 v105, v105, v112
    v_mul_f32 v105, s34, v105
    v_exp_f32 v105, v105
    v_sub_f32 v106, v106, v112
    v_mul_f32 v106, s34, v106
    v_exp_f32 v106, v106
    v_sub_f32 v107, v107, v112
    v_mul_f32 v107, s34, v107
    v_exp_f32 v107, v107
    v_sub_f32 v108, v108, v112
    v_mul_f32 v108, s34, v108
    v_exp_f32 v108, v108
    v_sub_f32 v109, v109, v112
    v_mul_f32 v109, s34, v109
    v_exp_f32 v109, v109
    v_sub_f32 v110, v110, v112
    v_mul_f32 v110, s34, v110
    v_exp_f32 v110, v110
    v_sub_f32 v111, v111, v112
    v_mul_f32 v111, s34, v111
    v_exp_f32 v111, v111
    s_nop 0
    v_add_f32 v113, v96, v97
    v_add_f32 v113, v113, v98
    v_add_f32 v113, v113, v99
    v_add_f32 v113, v113, v100
    v_add_f32 v113, v113, v101
    v_add_f32 v113, v113, v102
    v_add_f32 v113, v113, v103
    v_add_f32 v113, v113, v104
    v_add_f32 v113, v113, v105
    v_add_f32 v113, v113, v106
    v_add_f32 v113, v113, v107
    v_add_f32 v113, v113, v108
    v_add_f32 v113, v113, v109
    v_add_f32 v113, v113, v110
    v_add_f32 v113, v113, v111
    v_mov_b32 v8, v113
    s_nop 1
    v_permlane16_swap_b32 v113, v8
    s_nop 0
    v_add_f32 v113, v113, v8
    v_mov_b32 v8, v113
    s_nop 1
    v_permlane32_swap_b32 v113, v8
    s_nop 0
    v_add_f32 v113, v113, v8
    s_lshl_b32 s33, s31, 2
    s_add_u32 s33, s33, 134784
    v_add_u32 v9, s33, v7
    ds_write_b32 v9, v113
    v_cvt_pk_bf16_f32 v96, v96, v96
    v_cvt_pk_bf16_f32 v97, v97, v97
    v_cvt_pk_bf16_f32 v98, v98, v98
    v_cvt_pk_bf16_f32 v99, v99, v99
    v_cvt_pk_bf16_f32 v100, v100, v100
    v_cvt_pk_bf16_f32 v101, v101, v101
    v_cvt_pk_bf16_f32 v102, v102, v102
    v_cvt_pk_bf16_f32 v103, v103, v103
    v_cvt_pk_bf16_f32 v104, v104, v104
    v_cvt_pk_bf16_f32 v105, v105, v105
    v_cvt_pk_bf16_f32 v106, v106, v106
    v_cvt_pk_bf16_f32 v107, v107, v107
    v_cvt_pk_bf16_f32 v108, v108, v108
    v_cvt_pk_bf16_f32 v109, v109, v109
    v_cvt_pk_bf16_f32 v110, v110, v110
    v_cvt_pk_bf16_f32 v111, v111, v111
    v_and_b32 v7, 3, v3
    v_lshlrev_b32 v7, 7, v7
    v_lshl_add_u32 v7, v4, 5, v7
    s_lshl_b32 s33, s31, 10
    s_add_u32 s33, s33, 135168
    v_add_u32 v7, s33, v7
    v_cmp_gt_u32 vcc, 4, v3
    s_and_saveexec_b64 s[36:37], vcc
    ds_write_b128 v7, v[96:99] offset:0
    ds_write_b128 v7, v[100:103] offset:16
    ds_write_b128 v7, v[104:107] offset:512
    ds_write_b128 v7, v[108:111] offset:528
    s_mov_b64 exec, s[36:37]
    s_waitcnt lgkmcnt(0)
    v_mov_b32 v123, 1
    s_mov_b64 s[36:37], exec
    s_mov_b64 exec, 1
    ds_add_u32 v125, v123 offset:20
    s_mov_b64 exec, s[36:37]
    s_cmp_lt_u32 s31, 2
    s_cbranch_scc1 L_nohg
L_hg:
    v_and_b32 v5, 3, v2
    v_mul_u32_u24 v5, 114688, v5
    v_bfe_u32 v6, v2, 2, 1
    v_mul_u32_u24 v6, 440, v6
    v_add_u32 v5, v5, v6
    s_mul_i32 s32, s21, 448
    s_add_u32 s32, s32, 1148928
    v_add_u32 v5, s32, v5
    s_mov_b32 s96, 0
L_sh:
    global_load_dwordx2 v[16:17], v5, s[88:89] sc1
    s_waitcnt vmcnt(0)
    v_cmp_ne_u32 vcc, s95, v17
    s_cbranch_vccz L_sh_done
    s_sleep 2
    s_add_u32 s96, s96, 1
    s_cmp_lt_u32 s96, 4000
    s_cbranch_scc1 L_sh
L_sh_done:
    s_sub_u32 s32, s31, 2
    s_lshl_b32 s32, s32, 6
    v_add_u32 v5, s32, v2
    v_lshrrev_b32 v6, 4, v5
    v_and_b32 v7, 15, v5
    v_min_u32 v8, 13, v7
    v_mul_u32_u24 v9, 14336, v6
    v_lshl_add_u32 v9, v8, 5, v9
    s_mul_i32 s32, s21, 448
    s_add_u32 s32, s32, 1048576
    v_add_u32 v9, s32, v9
    s_mul_i32 s32, s21, 112
    v_lshlrev_b32 v10, 3, v8
    v_add_u32 v10, s32, v10
    global_load_dwordx2 v[52:53], v10, s[78:79]
    v_add_u32 v10, 0, v9
    v_add_u32 v11, 114688, v9
    v_add_u32 v12, 229376, v9
    v_add_u32 v13, 344064, v9
    s_mov_b32 s96, 0
L_ph:
    global_load_dwordx4 v[16:19], v10, s[88:89] sc1
    global_load_dwordx4 v[20:23], v10, s[88:89] offset:16 sc1
    global_load_dwordx4 v[24:27], v11, s[88:89] sc1
    global_load_dwordx4 v[28:31], v11, s[88:89] offset:16 sc1
    global_load_dwordx4 v[32:35], v12, s[88:89] sc1
    global_load_dwordx4 v[36:39], v12, s[88:89] offset:16 sc1
    global_load_dwordx4 v[40:43], v13, s[88:89] sc1
    global_load_dwordx4 v[44:47], v13, s[88:89] offset:16 sc1
    s_waitcnt vmcnt(0)
    v_cmp_ne_u32 s[38:39], s95, v17
    v_cmp_ne_u32 vcc, s95, v19
    s_or_b64 s[38:39], s[38:39], vcc
    v_cmp_ne_u32 vcc, s95, v21
    s_or_b64 s[38:39], s[38:39], vcc
    v_cmp_ne_u32 vcc, s95, v23
    s_or_b64 s[38:39], s[38:39], vcc
    v_cmp_ne_u32 vcc, s95, v25
    s_or_b64 s[38:39], s[38:39], vcc
    v_cmp_ne_u32 vcc, s95, v27
    s_or_b64 s[38:39], s[38:39], vcc
    v_cmp_ne_u32 vcc, s95, v29
    s_or_b64 s[38:39], s[38:39], vcc
    v_cmp_ne_u32 vcc, s95, v31
    s_or_b64 s[38:39], s[38:39], vcc
    v_cmp_ne_u32 vcc, s95, v33
    s_or_b64 s[38:39], s[38:39], vcc
    v_cmp_ne_u32 vcc, s95, v35
    s_or_b64 s[38:39], s[38:39], vcc
    v_cmp_ne_u32 vcc, s95, v37
    s_or_b64 s[38:39], s[38:39], vcc
    v_cmp_ne_u32 vcc, s95, v39
    s_or_b64 s[38:39], s[38:39], vcc
    v_cmp_ne_u32 vcc, s95, v41
    s_or_b64 s[38:39], s[38:39], vcc
    v_cmp_ne_u32 vcc, s95, v43
    s_or_b64 s[38:39], s[38:39], vcc
    v_cmp_ne_u32 vcc, s95, v45
    s_or_b64 s[38:39], s[38:39], vcc
    v_cmp_ne_u32 vcc, s95, v47
    s_or_b64 s[38:39], s[38:39], vcc
    s_mov_b64 vcc, s[38:39]
    s_cbranch_vccz L_ph_done
    s_sleep 2
    s_add_u32 s96, s96, 1
    s_cmp_lt_u32 s96, 4000
    s_cbranch_scc1 L_ph
L_ph_done:
    v_add_f32 v16, v16, v24
    v_add_f32 v32, v32, v40
    v_add_f32 v16, v16, v32
    v_cvt_pk_bf16_f32 v16, v16, v16
    v_lshlrev_b32 v16, 16, v16
    v_add_f32 v18, v18, v26
    v_add_f32 v34, v34, v42
    v_add_f32 v17, v18, v34
    v_cvt_pk_bf16_f32 v17, v17, v17
    v_lshlrev_b32 v17, 16, v17
    v_add_f32 v20, v20, v28
    v_add_f32 v36, v36, v44
    v_add_f32 v18, v20, v36
    v_cvt_pk_bf16_f32 v18, v18, v18
    v_lshlrev_b32 v18, 16, v18
    v_add_f32 v22, v22, v30
    v_add_f32 v38, v38, v46
    v_add_f32 v19, v22, v38
    v_cvt_pk_bf16_f32 v19, v19, v19
    v_lshlrev_b32 v19, 16, v19
    v_lshlrev_b32 v20, 16, v52
    v_and_b32 v21, 0xffff0000, v52
    v_lshlrev_b32 v22, 16, v53
    v_and_b32 v23, 0xffff0000, v53
    s_mov_b32 s32, 0x3d372713
    s_mov_b32 s33, 0x40135761
    v_add_f32 v16, v16, v20
    v_cvt_pk_bf16_f32 v16, v16, v16
    v_lshlrev_b32 v16, 16, v16
    v_mul_f32 v24, v16, v16
    v_mul_f32 v24, s32, v24
    v_fma_f32 v24, v24, v16, v16
    v_mul_f32 v24, s33, v24
    v_exp_f32 v24, v24
    s_nop 0
    v_add_f32 v24, 1.0, v24
    v_rcp_f32 v24, v24
    s_nop 0
    v_fma_f32 v24, v24, -2.0, 1.0
    v_add_f32 v24, 1.0, v24
    v_mul_f32 v24, v24, v16
    v_mul_f32 v16, 0.5, v24
    v_add_f32 v17, v17, v21
    v_cvt_pk_bf16_f32 v17, v17, v17
    v_lshlrev_b32 v17, 16, v17
    v_mul_f32 v24, v17, v17
    v_mul_f32 v24, s32, v24
    v_fma_f32 v24, v24, v17, v17
    v_mul_f32 v24, s33, v24
    v_exp_f32 v24, v24
    s_nop 0
    v_add_f32 v24, 1.0, v24
    v_rcp_f32 v24, v24
    s_nop 0
    v_fma_f32 v24, v24, -2.0, 1.0
    v_add_f32 v24, 1.0, v24
    v_mul_f32 v24, v24, v17
    v_mul_f32 v17, 0.5, v24
    v_add_f32 v18, v18, v22
    v_cvt_pk_bf16_f32 v18, v18, v18
    v_lshlrev_b32 v18, 16, v18
    v_mul_f32 v24, v18, v18
    v_mul_f32 v24, s32, v24
    v_fma_f32 v24, v24, v18, v18
    v_mul_f32 v24, s33, v24
    v_exp_f32 v24, v24
    s_nop 0
    v_add_f32 v24, 1.0, v24
    v_rcp_f32 v24, v24
    s_nop 0
    v_fma_f32 v24, v24, -2.0, 1.0
    v_add_f32 v24, 1.0, v24
    v_mul_f32 v24, v24, v18
    v_mul_f32 v18, 0.5, v24
    v_add_f32 v19, v19, v23
    v_cvt_pk_bf16_f32 v19, v19, v19
    v_lshlrev_b32 v19, 16, v19
    v_mul_f32 v24, v19, v19
    v_mul_f32 v24, s32, v24
    v_fma_f32 v24, v24, v19, v19
    v_mul_f32 v24, s33, v24
    v_exp_f32 v24, v24
    s_nop 0
    v_add_f32 v24, 1.0, v24
    v_rcp_f32 v24, v24
    s_nop 0
    v_fma_f32 v24, v24, -2.0, 1.0
    v_add_f32 v24, 1.0, v24
    v_mul_f32 v24, v24, v19
    v_mul_f32 v19, 0.5, v24
    v_cvt_pk_bf16_f32 v20, v16, v17
    v_cvt_pk_bf16_f32 v21, v18, v19
    v_cmp_gt_u32 vcc, 14, v7
    s_nop 1
    v_cndmask_b32 v20, 0, v20, vcc
    v_cndmask_b32 v21, 0, v21, vcc
    v_mul_u32_u24 v9, 144, v6
    v_lshl_add_u32 v9, v7, 3, v9
    v_add_u32 v9, 132352, v9
    ds_write_b64 v9, v[20:21]
    s_waitcnt lgkmcnt(0)
    v_mov_b32 v123, 1
    s_mov_b64 s[36:37], exec
    s_mov_b64 exec, 1
    ds_add_u32 v125, v123 offset:28
    s_mov_b64 exec, s[36:37]
L_nohg:
    s_cmp_lg_u32 s31, 1
    s_cbranch_scc1 L_nfl
    v_lshlrev_b32 v7, 5, v2
    v_add_u32 v7, 7340032, v7
    s_mov_b32 s96, 0
L_pfl:
    global_load_dwordx4 v[16:19], v7, s[88:89] sc1
    global_load_dwordx4 v[20:23], v7, s[88:89] offset:16 sc1
    s_waitcnt vmcnt(0)
    v_cmp_ne_u32 s[38:39], s95, v17
    v_cmp_ne_u32 vcc, s95, v19
    s_or_b64 s[38:39], s[38:39], vcc
    v_cmp_ne_u32 vcc, s95, v21
    s_or_b64 s[38:39], s[38:39], vcc
    v_cmp_ne_u32 vcc, s95, v23
    s_or_b64 s[38:39], s[38:39], vcc
    s_mov_b64 vcc, s[38:39]
    s_cbranch_vccz L_pfl_done
    s_sleep 2
    s_add_u32 s96, s96, 1
    s_cmp_lt_u32 s96, 4000
    s_cbranch_scc1 L_pfl
L_pfl_done:
    v_mov_b32 v16, 1
    ds_write_b32 v125, v16 offset:12
L_nfl:
    s_mov_b32 s96, 0
L_lw9:
    ds_read_b32 v123, v125 offset:28
    s_waitcnt lgkmcnt(0)
    v_cmp_gt_u32 vcc, 2, v123
    s_cbranch_vccz L_lw9_d
    s_sleep 1
    s_add_u32 s96, s96, 1
    s_cmp_lt_u32 s96, 4000
    s_cbranch_scc1 L_lw9
L_lw9_d:
    v_and_b32 v5, 7, v3
    v_mul_u32_u24 v5, 144, v5
    v_lshl_add_u32 v5, v4, 4, v5
    v_add_u32 v5, 132352, v5
    ds_read_b128 v[16:19], v5
    ds_read_b128 v[20:23], v5 offset:64
    v_lshrrev_b32 v6, 2, v3
    v_lshl_add_u32 v6, v4, 3, v6
    v_lshlrev_b32 v6, 7, v6
    v_and_b32 v7, 3, v3
    v_lshl_add_u32 v6, v7, 3, v6
    s_lshl_b32 s32, s31, 5
    s_add_u32 s32, s32, 114688
    v_add_u32 v6, s32, v6
    ds_read_b64_tr_b16 v[32:33], v6 offset:0
    ds_read_b64_tr_b16 v[34:35], v6 offset:512
    ds_read_b64_tr_b16 v[36:37], v6 offset:4096
    ds_read_b64_tr_b16 v[38:39], v6 offset:4608
    v_mov_b32 v48, 0
    v_mov_b32 v49, 0
    v_mov_b32 v50, 0
    v_mov_b32 v51, 0
    v_lshlrev_b32 v7, 10, v4
    v_lshl_add_u32 v7, v3, 2, v7
    s_lshl_b32 s32, s2, 11
    s_lshl_b32 s33, s31, 6
    s_add_u32 s32, s32, s33
    s_add_u32 s32, s32, 6291456
    v_add_u32 v7, s32, v7
    s_waitcnt lgkmcnt(0)
    v_mfma_f32_16x16x32_bf16 v[48:51], v[16:19], v[32:35], v[48:51]
    v_mfma_f32_16x16x32_bf16 v[48:51], v[20:23], v[36:39], v[48:51]
    s_nop 9
    v_cmp_eq_u32 vcc, -1, v48
    s_nop 1
    v_cndmask_b32 v48, v48, v124, vcc
    v_cmp_eq_u32 vcc, -1, v49
    s_nop 1
    v_cndmask_b32 v49, v49, v124, vcc
    v_cmp_eq_u32 vcc, -1, v50
    s_nop 1
    v_cndmask_b32 v50, v50, v124, vcc
    v_cmp_eq_u32 vcc, -1, v51
    s_nop 1
    v_cndmask_b32 v51, v51, v124, vcc
    v_cmp_gt_u32 vcc, 32, v2
    s_and_saveexec_b64 s[36:37], vcc
    global_store_dword v7, v48, s[88:89] offset:0 sc1
    global_store_dword v7, v49, s[88:89] offset:256 sc1
    global_store_dword v7, v50, s[88:89] offset:512 sc1
    global_store_dword v7, v51, s[88:89] offset:768 sc1
    s_mov_b64 exec, s[36:37]
    s_cmp_lg_u32 s31, 0
    s_cbranch_scc1 L_end
    s_mov_b32 s96, 0
L_lw10:
    ds_read_b32 v123, v125 offset:12
    s_waitcnt lgkmcnt(0)
    v_cmp_gt_u32 vcc, 1, v123
    s_cbranch_vccz L_lw10_d
    s_sleep 1
    s_add_u32 s96, s96, 1
    s_cmp_lt_u32 s96, 4000
    s_cbranch_scc1 L_lw10
L_lw10_d:
    v_lshrrev_b32 v5, 2, v2
    v_and_b32 v6, 3, v2
    v_lshlrev_b32 v7, 14, v5
    v_lshl_add_u32 v7, v6, 4, v7
    s_lshl_b32 s32, s20, 11
    s_lshl_b32 s33, s22, 8
    s_add_u32 s32, s32, s33
    s_lshl_b32 s33, s23, 6
    s_add_u32 s32, s32, s33
    s_add_u32 s32, s32, 6291456
    v_add_u32 v7, s32, v7
    v_add_u32 v8, 0x40000, v7
    s_lshl_b32 s32, s20, 7
    s_lshl_b32 s33, s23, 5
    s_add_u32 s32, s32, s33
    v_lshlrev_b32 v9, 3, v6
    v_add_u32 v9, s32, v9
    global_load_dwordx2 v[100:101], v9, s[82:83]
    s_lshl_b32 s33, s22, 10
    v_add_u32 v10, s33, v9
    global_load_dwordx2 v[102:103], v10, s[64:65]
    s_mov_b32 s96, 0
L_py:
    global_load_dwordx4 v[16:19], v7, s[88:89] sc1
    global_load_dwordx4 v[20:23], v8, s[88:89] sc1
    s_waitcnt vmcnt(0)
    v_cmp_eq_u32 s[38:39], -1, v16
    v_cmp_eq_u32 vcc, -1, v17
    s_or_b64 s[38:39], s[38:39], vcc
    v_cmp_eq_u32 vcc, -1, v18
    s_or_b64 s[38:39], s[38:39], vcc
    v_cmp_eq_u32 vcc, -1, v19
    s_or_b64 s[38:39], s[38:39], vcc
    v_cmp_eq_u32 vcc, -1, v20
    s_or_b64 s[38:39], s[38:39], vcc
    v_cmp_eq_u32 vcc, -1, v21
    s_or_b64 s[38:39], s[38:39], vcc
    v_cmp_eq_u32 vcc, -1, v22
    s_or_b64 s[38:39], s[38:39], vcc
    v_cmp_eq_u32 vcc, -1, v23
    s_or_b64 s[38:39], s[38:39], vcc
    s_mov_b64 vcc, s[38:39]
    s_cbranch_vccz L_py_done
    s_sleep 2
    s_add_u32 s96, s96, 1
    s_cmp_lt_u32 s96, 4000
    s_cbranch_scc1 L_py
L_py_done:
    v_add_f32 v104, v16, v20
    v_add_f32 v105, v17, v21
    v_add_f32 v106, v18, v22
    v_add_f32 v107, v19, v23
    s_nop 1
    v_add_f32_dpp v104, v104, v104 row_shr:4 row_mask:0xf bank_mask:0xf bound_ctrl:0
    s_nop 1
    v_add_f32_dpp v105, v105, v105 row_shr:4 row_mask:0xf bank_mask:0xf bound_ctrl:0
    s_nop 1
    v_add_f32_dpp v106, v106, v106 row_shr:4 row_mask:0xf bank_mask:0xf bound_ctrl:0
    s_nop 1
    v_add_f32_dpp v107, v107, v107 row_shr:4 row_mask:0xf bank_mask:0xf bound_ctrl:0
    s_nop 1
    v_add_f32_dpp v104, v104, v104 row_shr:8 row_mask:0xf bank_mask:0xf bound_ctrl:0
    s_nop 1
    v_add_f32_dpp v105, v105, v105 row_shr:8 row_mask:0xf bank_mask:0xf bound_ctrl:0
    s_nop 1
    v_add_f32_dpp v106, v106, v106 row_shr:8 row_mask:0xf bank_mask:0xf bound_ctrl:0
    s_nop 1
    v_add_f32_dpp v107, v107, v107 row_shr:8 row_mask:0xf bank_mask:0xf bound_ctrl:0
    v_mov_b32 v11, v104
    s_nop 1
    v_permlane16_swap_b32 v104, v11
    s_nop 0
    v_add_f32 v104, v104, v11
    v_mov_b32 v11, v104
    s_nop 1
    v_permlane32_swap_b32 v104, v11
    s_nop 0
    v_add_f32 v104, v104, v11
    v_mov_b32 v11, v105
    s_nop 1
    v_permlane16_swap_b32 v105, v11
    s_nop 0
    v_add_f32 v105, v105, v11
    v_mov_b32 v11, v105
    s_nop 1
    v_permlane32_swap_b32 v105, v11
    s_nop 0
    v_add_f32 v105, v105, v11
    v_mov_b32 v11, v106
    s_nop 1
    v_permlane16_swap_b32 v106, v11
    s_nop 0
    v_add_f32 v106, v106, v11
    v_mov_b32 v11, v106
    s_nop 1
    v_permlane32_swap_b32 v106, v11
    s_nop 0
    v_add_f32 v106, v106, v11
    v_mov_b32 v11, v107
    s_nop 1
    v_permlane16_swap_b32 v107, v11
    s_nop 0
    v_add_f32 v107, v107, v11
    v_mov_b32 v11, v107
    s_nop 1
    v_permlane32_swap_b32 v107, v11
    s_nop 0
    v_add_f32 v107, v107, v11
    v_lshlrev_b32 v20, 16, v100
    v_and_b32 v21, 0xffff0000, v100
    v_lshlrev_b32 v22, 16, v101
    v_and_b32 v23, 0xffff0000, v101
    v_cvt_pk_bf16_f32 v104, v104, v104
    v_lshlrev_b32 v104, 16, v104
    v_add_f32 v104, v104, v20
    v_cvt_pk_bf16_f32 v104, v104, v104
    v_lshlrev_b32 v104, 16, v104
    v_mul_f32 v24, 0xbfb8aa3b, v104
    v_exp_f32 v24, v24
    s_nop 0
    v_add_f32 v24, 1.0, v24
    v_rcp_f32 v24, v24
    s_nop 0
    v_mul_f32 v104, v104, v24
    v_cvt_pk_bf16_f32 v104, v104, v104
    v_lshlrev_b32 v104, 16, v104
    v_cvt_pk_bf16_f32 v105, v105, v105
    v_lshlrev_b32 v105, 16, v105
    v_add_f32 v105, v105, v21
    v_cvt_pk_bf16_f32 v105, v105, v105
    v_lshlrev_b32 v105, 16, v105
    v_mul_f32 v24, 0xbfb8aa3b, v105
    v_exp_f32 v24, v24
    s_nop 0
    v_add_f32 v24, 1.0, v24
    v_rcp_f32 v24, v24
    s_nop 0
    v_mul_f32 v105, v105, v24
    v_cvt_pk_bf16_f32 v105, v105, v105
    v_lshlrev_b32 v105, 16, v105
    v_cvt_pk_bf16_f32 v106, v106, v106
    v_lshlrev_b32 v106, 16, v106
    v_add_f32 v106, v106, v22
    v_cvt_pk_bf16_f32 v106, v106, v106
    v_lshlrev_b32 v106, 16, v106
    v_mul_f32 v24, 0xbfb8aa3b, v106
    v_exp_f32 v24, v24
    s_nop 0
    v_add_f32 v24, 1.0, v24
    v_rcp_f32 v24, v24
    s_nop 0
    v_mul_f32 v106, v106, v24
    v_cvt_pk_bf16_f32 v106, v106, v106
    v_lshlrev_b32 v106, 16, v106
    v_cvt_pk_bf16_f32 v107, v107, v107
    v_lshlrev_b32 v107, 16, v107
    v_add_f32 v107, v107, v23
    v_cvt_pk_bf16_f32 v107, v107, v107
    v_lshlrev_b32 v107, 16, v107
    v_mul_f32 v24, 0xbfb8aa3b, v107
    v_exp_f32 v24, v24
    s_nop 0
    v_add_f32 v24, 1.0, v24
    v_rcp_f32 v24, v24
    s_nop 0
    v_mul_f32 v107, v107, v24
    v_cvt_pk_bf16_f32 v107, v107, v107
    v_lshlrev_b32 v107, 16, v107
    v_and_b32 v7, 7, v5
    v_lshrrev_b32 v8, 3, v5
    v_lshl_add_u32 v7, v8, 5, v7
    v_lshlrev_b32 v7, 12, v7
    v_lshl_add_u32 v7, v6, 4, v7
    s_lshr_b32 s32, s20, 1
    s_lshl_b32 s32, s32, 15
    s_lshl_b32 s33, s22, 9
    s_add_u32 s32, s32, s33
    s_and_b32 s33, s20, 1
    s_lshl_b32 s33, s33, 2
    s_add_u32 s33, s33, s23
    s_lshl_b32 s33, s33, 6
    s_add_u32 s32, s32, s33
    s_add_u32 s32, s32, 4194304
    v_add_u32 v108, s32, v7
    v_add_u32 v109, 262144, v108
    v_add_u32 v110, 524288, v108
    v_add_u32 v111, 786432, v108
    s_mov_b32 s96, 0
L_pz:
    global_load_dwordx4 v[16:19], v108, s[88:89] sc1
    global_load_dwordx4 v[20:23], v109, s[88:89] sc1
    global_load_dwordx4 v[24:27], v110, s[88:89] sc1
    global_load_dwordx4 v[28:31], v111, s[88:89] sc1
    s_waitcnt vmcnt(0)
    v_cmp_eq_u32 s[38:39], -1, v16
    v_cmp_eq_u32 vcc, -1, v17
    s_or_b64 s[38:39], s[38:39], vcc
    v_cmp_eq_u32 vcc, -1, v18
    s_or_b64 s[38:39], s[38:39], vcc
    v_cmp_eq_u32 vcc, -1, v19
    s_or_b64 s[38:39], s[38:39], vcc
    v_cmp_eq_u32 vcc, -1, v20
    s_or_b64 s[38:39], s[38:39], vcc
    v_cmp_eq_u32 vcc, -1, v21
    s_or_b64 s[38:39], s[38:39], vcc
    v_cmp_eq_u32 vcc, -1, v22
    s_or_b64 s[38:39], s[38:39], vcc
    v_cmp_eq_u32 vcc, -1, v23
    s_or_b64 s[38:39], s[38:39], vcc
    v_cmp_eq_u32 vcc, -1, v24
    s_or_b64 s[38:39], s[38:39], vcc
    v_cmp_eq_u32 vcc, -1, v25
    s_or_b64 s[38:39], s[38:39], vcc
    v_cmp_eq_u32 vcc, -1, v26
    s_or_b64 s[38:39], s[38:39], vcc
    v_cmp_eq_u32 vcc, -1, v27
    s_or_b64 s[38:39], s[38:39], vcc
    v_cmp_eq_u32 vcc, -1, v28
    s_or_b64 s[38:39], s[38:39], vcc
    v_cmp_eq_u32 vcc, -1, v29
    s_or_b64 s[38:39], s[38:39], vcc
    v_cmp_eq_u32 vcc, -1, v30
    s_or_b64 s[38:39], s[38:39], vcc
    v_cmp_eq_u32 vcc, -1, v31
    s_or_b64 s[38:39], s[38:39], vcc
    s_mov_b64 vcc, s[38:39]
    s_cbranch_vccz L_pz_done
    s_sleep 1
    s_add_u32 s96, s96, 1
    s_cmp_lt_u32 s96, 4000
    s_cbranch_scc1 L_pz
L_pz_done:
    v_add_f32 v16, v16, v20
    v_add_f32 v24, v24, v28
    v_add_f32 v112, v16, v24
    v_add_f32 v17, v17, v21
    v_add_f32 v25, v25, v29
    v_add_f32 v113, v17, v25
    v_add_f32 v18, v18, v22
    v_add_f32 v26, v26, v30
    v_add_f32 v114, v18, v26
    v_add_f32 v19, v19, v23
    v_add_f32 v27, v27, v31
    v_add_f32 v115, v19, v27
    s_nop 1
    v_add_f32_dpp v112, v112, v112 row_shr:4 row_mask:0xf bank_mask:0xf bound_ctrl:0
    s_nop 1
    v_add_f32_dpp v113, v113, v113 row_shr:4 row_mask:0xf bank_mask:0xf bound_ctrl:0
    s_nop 1
    v_add_f32_dpp v114, v114, v114 row_shr:4 row_mask:0xf bank_mask:0xf bound_ctrl:0
    s_nop 1
    v_add_f32_dpp v115, v115, v115 row_shr:4 row_mask:0xf bank_mask:0xf bound_ctrl:0
    s_nop 1
    v_add_f32_dpp v112, v112, v112 row_shr:8 row_mask:0xf bank_mask:0xf bound_ctrl:0
    s_nop 1
    v_add_f32_dpp v113, v113, v113 row_shr:8 row_mask:0xf bank_mask:0xf bound_ctrl:0
    s_nop 1
    v_add_f32_dpp v114, v114, v114 row_shr:8 row_mask:0xf bank_mask:0xf bound_ctrl:0
    s_nop 1
    v_add_f32_dpp v115, v115, v115 row_shr:8 row_mask:0xf bank_mask:0xf bound_ctrl:0
    v_mov_b32 v11, v112
    s_nop 1
    v_permlane16_swap_b32 v112, v11
    s_nop 0
    v_add_f32 v112, v112, v11
    v_mov_b32 v11, v112
    s_nop 1
    v_permlane32_swap_b32 v112, v11
    s_nop 0
    v_add_f32 v112, v112, v11
    v_mov_b32 v11, v113
    s_nop 1
    v_permlane16_swap_b32 v113, v11
    s_nop 0
    v_add_f32 v113, v113, v11
    v_mov_b32 v11, v113
    s_nop 1
    v_permlane32_swap_b32 v113, v11
    s_nop 0
    v_add_f32 v113, v113, v11
    v_mov_b32 v11, v114
    s_nop 1
    v_permlane16_swap_b32 v114, v11
    s_nop 0
    v_add_f32 v114, v114, v11
    v_mov_b32 v11, v114
    s_nop 1
    v_permlane32_swap_b32 v114, v11
    s_nop 0
    v_add_f32 v114, v114, v11
    v_mov_b32 v11, v115
    s_nop 1
    v_permlane16_swap_b32 v115, v11
    s_nop 0
    v_add_f32 v115, v115, v11
    v_mov_b32 v11, v115
    s_nop 1
    v_permlane32_swap_b32 v115, v11
    s_nop 0
    v_add_f32 v115, v115, v11
    v_lshlrev_b32 v20, 16, v102
    v_and_b32 v21, 0xffff0000, v102
    v_lshlrev_b32 v22, 16, v103
    v_and_b32 v23, 0xffff0000, v103
    v_cvt_pk_bf16_f32 v112, v112, v112
    v_lshlrev_b32 v112, 16, v112
    v_mul_f32 v112, v112, v104
    v_cvt_pk_bf16_f32 v112, v112, v112
    v_lshlrev_b32 v112, 16, v112
    v_add_f32 v112, v112, v20
    v_cvt_pk_bf16_f32 v113, v113, v113
    v_lshlrev_b32 v113, 16, v113
    v_mul_f32 v113, v113, v105
    v_cvt_pk_bf16_f32 v113, v113, v113
    v_lshlrev_b32 v113, 16, v113
    v_add_f32 v113, v113, v21
    v_cvt_pk_bf16_f32 v114, v114, v114
    v_lshlrev_b32 v114, 16, v114
    v_mul_f32 v114, v114, v106
    v_cvt_pk_bf16_f32 v114, v114, v114
    v_lshlrev_b32 v114, 16, v114
    v_add_f32 v114, v114, v22
    v_cvt_pk_bf16_f32 v115, v115, v115
    v_lshlrev_b32 v115, 16, v115
    v_mul_f32 v115, v115, v107
    v_cvt_pk_bf16_f32 v115, v115, v115
    v_lshlrev_b32 v115, 16, v115
    v_add_f32 v115, v115, v23
    v_cvt_pk_bf16_f32 v28, v112, v113
    v_cvt_pk_bf16_f32 v29, v114, v115
    v_cmp_le_u32 vcc, 12, v2
    v_cmp_gt_u32 s[36:37], 16, v2
    s_and_b64 vcc, vcc, s[36:37]
    s_and_saveexec_b64 s[36:37], vcc
    global_store_dwordx2 v10, v[28:29], s[84:85]
L_end:
    s_endpgm
.section .rodata,"a"
.p2align 6
.amdhsa_kernel recurrent_scan__sliding_block_cached__dense_activation_gelu__decode_kernel
  .amdhsa_next_free_vgpr 128
  .amdhsa_next_free_sgpr 102
  .amdhsa_accum_offset 128
  .amdhsa_group_segment_fixed_size 0
  .amdhsa_kernarg_size 104
  .amdhsa_user_sgpr_count 2
  .amdhsa_user_sgpr_kernarg_segment_ptr 1
  .amdhsa_system_sgpr_workgroup_id_x 1
.end_amdhsa_kernel
```
